```python
import torch

def _softmax(x, axis=-1):
    return torch.softmax(x, dim=axis)
def _gelu(x):
    return torch.nn.functional.gelu(x, approximate="tanh")
def _silu(x):
    return torch.nn.functional.silu(x)
def _sigmoid(x):
    return torch.sigmoid(x)
def _layernorm(x, axis=-1, eps=1e-5):
    m = x.mean(dim=axis, keepdim=True)
    v = x.var(dim=axis, keepdim=True, unbiased=False)
    return (x - m) / torch.sqrt(v + eps)
def _scatter_add(tgt, idx, src, axis=0):
    return tgt.clone().index_add_(axis, idx, src)
def _segment_sum(src, seg, n):
    out = torch.zeros((n,) + src.shape[1:], dtype=src.dtype)
    return out.index_add_(0, seg, src)
def _pad(x, pw):
    flat = tuple(v for pair in reversed(pw) for v in pair)
    return torch.nn.functional.pad(x, flat)

kernel_name = 'parallel_sum__sliding_local_dilated__mixer_token_mlp__prompt'

def setup_inputs():

    _w = (lambda a: (lambda t: t.to(torch.bfloat16) if t.is_floating_point() else t)(torch.as_tensor(a)))
    def _A_setup():
        B, S, D = 1, 2048, 640
        return {
            "x": _w((lambda *s: torch.randn(*s, dtype=torch.bfloat16) * 0.05)(B, S, D)),
            "wqkv": _w((lambda *s: torch.randn(*s, dtype=torch.bfloat16) * 0.05)(D, 3 * D)),
            "wo": _w((lambda *s: torch.randn(*s, dtype=torch.bfloat16) * 0.05)(D, D)),
        }
    _A_in = _A_setup()

    def _B_setup():
        B, S, D, F = 1, 2048, 640, 1728
        return {
            "x": _w((lambda *s: torch.randn(*s, dtype=torch.bfloat16) * 0.05)(B, S, D)),
            "w1": _w((lambda *s: torch.randn(*s, dtype=torch.bfloat16) * 0.8)(S, F) * (S ** -0.5)),
            "b1": _w((lambda *s: torch.randn(*s, dtype=torch.bfloat16) * 0.8)(F) * 0.02),
            "w2": _w((lambda *s: torch.randn(*s, dtype=torch.bfloat16) * 0.8)(F, S) * (F ** -0.5)),
            "b2": _w((lambda *s: torch.randn(*s, dtype=torch.bfloat16) * 0.8)(S) * 0.02),
        }
    _B_in = _B_setup()

    return {
        "A_x": _A_in["x"],
        "A_wqkv": _A_in["wqkv"],
        "A_wo": _A_in["wo"],
        "B_x": _B_in["x"],
        "B_w1": _B_in["w1"],
        "B_b1": _B_in["b1"],
        "B_w2": _B_in["w2"],
        "B_b2": _B_in["b2"],
    }

def reference(A_x, A_wqkv, A_wo, B_x, B_w1, B_b1, B_w2, B_b2):
    def _A_ref(x, wqkv, wo):
        B, S, D = x.shape
        H = 32; Dh = D // H
        W, dil = 8, 2
        qkv = (lambda x, *d: x.permute(*d))((x @ wqkv).reshape(B, S, 3, H, Dh), 2, 0, 3, 1, 4)
        q, k, v = qkv[0], qkv[1], qkv[2]
        scale = Dh ** -0.5
        pos = torch.arange(S)
        off = torch.arange(W) * dil
        idx = pos[:, None] - off[None, :]
        mask = idx >= 0
        idx_c = torch.where(mask, idx, 0).reshape(-1)
        kg = k[:, :, idx_c, :].reshape(B, H, S, W, Dh)
        vg = v[:, :, idx_c, :].reshape(B, H, S, W, Dh)
        logits = torch.einsum("bhsd,bhswd->bhsw", q, kg) * scale
        logits = torch.where(mask[None, None, :, :], logits, -1e9)
        attn = _softmax(logits, axis=-1)
        o = torch.einsum("bhsw,bhswd->bhsd", attn, vg)
        return (lambda x, *d: x.permute(*d))(o, 0, 2, 1, 3).reshape(B, S, D) @ wo

    def _B_ref(x, w1, b1, w2, b2):
        B, S, D = x.shape
        h = _layernorm(x, axis=-1)
        u = torch.einsum("bsd,sf->bdf", h, w1) + b1
        u = _gelu(u)
        y = torch.einsum("bdf,fs->bds", u, w2) + b2
        return (lambda x, *d: x.permute(*d))(y, 0, 2, 1)

    x = A_x
    xn = _layernorm(x, axis=-1)
    return x + _A_ref(xn, A_wqkv, A_wo) + _B_ref(xn, B_w1, B_b1, B_w2, B_b2)
```

```asm
; @launch grid=(256,1,1) block=(512,1,1) lds=163840
.amdgcn_target "amdgcn-amd-amdhsa--gfx950"
.text
.globl parallel_sum__sliding_local_dilated__mixer_token_mlp__prompt_kernel
.p2align 8
.type parallel_sum__sliding_local_dilated__mixer_token_mlp__prompt_kernel,@function
parallel_sum__sliding_local_dilated__mixer_token_mlp__prompt_kernel:
  s_cmp_ge_u32 s2, 256
  s_cbranch_scc1 L_end
  s_load_dwordx16 s[16:31], s[0:1], 0
  s_load_dwordx4 s[32:35], s[0:1], 64
  s_load_dwordx2 s[36:37], s[0:1], 80
  v_and_b32 v1, 63, v0
  v_lshrrev_b32 v2, 6, v0
  s_nop 0
  v_readfirstlane_b32 s40, v2
  s_nop 0
  s_sub_u32 s41, s40, 4
  s_cmp_lg_u32 s40, 7
  s_cbranch_scc1 Lcpf_1
  s_getpc_b64 s[4:5]
L_pcref:
  s_sub_u32 s4, s4, L_pcref-parallel_sum__sliding_local_dilated__mixer_token_mlp__prompt_kernel
  s_subb_u32 s5, s5, 0
  s_lshr_b32 s3, s2, 3
  s_mul_i32 s3, s3, 1280
  v_lshlrev_b32 v2, 7, v1
  v_add_u32 v2, s3, v2
  v_min_u32 v2, L_end-parallel_sum__sliding_local_dilated__mixer_token_mlp__prompt_kernel, v2
  s_mov_b64 exec, 1023
  global_load_dword v63, v2, s[4:5]
  s_mov_b64 exec, -1
Lcpf_1:
  v_lshlrev_b32 v2, 2, v1
  v_add_u32 v2, 163584, v2
  v_mov_b32 v3, 0
  ds_write_b32 v2, v3
  s_bfe_u32 s57, s2, 0x20001
  s_lshr_b32 s59, s2, 3
  s_lshl_b32 s39, s59, 2
  s_add_u32 s39, s39, s57
  s_bitcmp1_b32 s2, 0
  s_cbranch_scc1 L_roleA
  s_lshl_b32 s58, s39, 4
  s_lshl_b32 s44, s40, 1
  s_add_u32 s44, s44, s58
  v_lshrrev_b32 v6, 5, v1
  v_add_u32 v7, s44, v6
  v_mul_u32_u24 v6, 1280, v7
  v_and_b32 v2, 31, v1
  v_lshl_add_u32 v6, v2, 3, v6
  s_waitcnt lgkmcnt(0)
  s_mov_b32 s60, s16
  s_mov_b32 s61, s17
  s_mov_b32 s62, 2621440
  s_mov_b32 s63, 0x20000
  buffer_load_dwordx2 v[22:23], v6, s[60:63], 0 offen offset:0
  buffer_load_dwordx2 v[24:25], v6, s[60:63], 0 offen offset:256
  buffer_load_dwordx2 v[26:27], v6, s[60:63], 0 offen offset:512
  buffer_load_dwordx2 v[28:29], v6, s[60:63], 0 offen offset:768
  buffer_load_dwordx2 v[30:31], v6, s[60:63], 0 offen offset:1024
  s_mov_b32 s8, s34
  s_mov_b32 s9, s35
  s_mov_b32 s10, 256
  s_mov_b32 s11, 0x20000
  s_add_u32 s12, s36, 12730368
  s_addc_u32 s13, s37, 0
  s_mov_b32 s14, 3072
  s_mov_b32 s15, 0x20000
  s_add_u32 s64, s36, 4096
  s_addc_u32 s65, s37, 0
  s_mov_b32 s66, 2621440
  s_mov_b32 s67, 0x20000
  s_add_u32 s68, s36, 12713984
  s_addc_u32 s69, s37, 0
  s_mov_b32 s70, 16384
  s_mov_b32 s71, 0x20000
  s_lshl_b32 s44, s40, 1
  v_lshrrev_b32 v2, 5, v1
  v_add_u32 v2, s44, v2
  v_lshlrev_b32 v65, 3, v2
  v_add_u32 v65, 154112, v65
  v_mul_u32_u24 v2, 1312, v2
  v_and_b32 v3, 31, v1
  v_lshl_add_u32 v64, v3, 3, v2
  v_add_u32 v64, 133120, v64
  v_lshrrev_b32 v2, 4, v1
  v_and_b32 v3, 15, v1
  v_and_b32 v4, 1, v2
  v_lshlrev_b32 v4, 3, v4
  v_lshrrev_b32 v66, 2, v3
  v_add_u32 v4, v4, v66
  v_mul_u32_u24 v4, 1312, v4
  v_and_b32 v66, 3, v3
  v_lshl_add_u32 v4, v66, 3, v4
  v_lshrrev_b32 v2, 1, v2
  v_lshl_add_u32 v4, v2, 5, v4
  s_lshl_b32 s44, s40, 6
  s_add_u32 s44, s44, 133120
  v_add_u32 v66, s44, v4
  v_and_b32 v67, 31, v1
  v_lshlrev_b32 v67, 4, v67
  v_lshl_add_u32 v67, v2, 16, v67
  s_lshr_b32 s44, s39, 1
  s_lshl_b32 s44, s44, 10
  s_and_b32 s45, s39, 1
  s_lshl_b32 s45, s45, 9
  s_add_u32 s44, s44, s45
  s_lshl_b32 s45, s40, 17
  s_add_u32 s6, s44, s45
  s_lshr_b32 s44, s57, 1
  s_mul_i32 s43, s44, 7
  s_and_b32 s44, s57, 1
  s_lshl_b32 s44, s44, 2
  s_cmp_ge_u32 s59, 24
  s_cbranch_scc1 Lmap_2
  s_add_u32 s43, s43, s44
  s_lshr_b32 s45, s59, 3
  s_add_u32 s43, s43, s45
  s_and_b32 s42, s59, 7
  s_branch Lmap_3
Lmap_2:
  s_add_u32 s43, s43, 3
  s_sub_u32 s42, s59, 24
  s_add_u32 s42, s42, s44
  s_and_b32 s42, s42, 7
Lmap_3:
  s_lshr_b32 s45, s59, 3
  s_mul_i32 s45, s45, 0
  s_add_u32 s45, s45, s42
  s_and_b32 s45, s45, 7
  s_mul_i32 s38, s45, 4
  s_mov_b32 s22, s59
  s_mov_b32 s23, s38
  s_waitcnt vmcnt(0)
LB_xok:
  v_lshlrev_b32 v32, 16, v22
  v_and_b32 v33, 0xffff0000, v22
  v_lshlrev_b32 v34, 16, v23
  v_and_b32 v35, 0xffff0000, v23
  v_lshlrev_b32 v36, 16, v24
  v_and_b32 v37, 0xffff0000, v24
  v_lshlrev_b32 v38, 16, v25
  v_and_b32 v39, 0xffff0000, v25
  v_lshlrev_b32 v40, 16, v26
  v_and_b32 v41, 0xffff0000, v26
  v_lshlrev_b32 v42, 16, v27
  v_and_b32 v43, 0xffff0000, v27
  v_lshlrev_b32 v44, 16, v28
  v_and_b32 v45, 0xffff0000, v28
  v_lshlrev_b32 v46, 16, v29
  v_and_b32 v47, 0xffff0000, v29
  v_lshlrev_b32 v48, 16, v30
  v_and_b32 v49, 0xffff0000, v30
  v_lshlrev_b32 v50, 16, v31
  v_and_b32 v51, 0xffff0000, v31
  v_pk_add_f32 v[10:11], v[32:33], v[34:35]
  v_pk_add_f32 v[10:11], v[10:11], v[36:37]
  v_pk_add_f32 v[10:11], v[10:11], v[38:39]
  v_pk_add_f32 v[10:11], v[10:11], v[40:41]
  v_pk_add_f32 v[10:11], v[10:11], v[42:43]
  v_pk_add_f32 v[10:11], v[10:11], v[44:45]
  v_pk_add_f32 v[10:11], v[10:11], v[46:47]
  v_pk_add_f32 v[10:11], v[10:11], v[48:49]
  v_pk_add_f32 v[10:11], v[10:11], v[50:51]
  v_add_f32 v12, v10, v11
  s_nop 1
  v_add_f32_dpp v12, v12, v12 row_ror:8 row_mask:0xf bank_mask:0xf
  s_nop 1
  v_add_f32_dpp v12, v12, v12 row_ror:4 row_mask:0xf bank_mask:0xf
  s_nop 1
  v_add_f32_dpp v12, v12, v12 row_ror:2 row_mask:0xf bank_mask:0xf
  s_nop 1
  v_add_f32_dpp v12, v12, v12 row_ror:1 row_mask:0xf bank_mask:0xf
  v_mov_b32 v10, v12
  s_nop 1
  v_permlane16_swap_b32 v12, v10
  v_add_f32 v12, v12, v10
  v_mul_f32 v14, 0x3acccccd, v12
  v_pk_add_f32 v[32:33], v[32:33], v[14:15] op_sel_hi:[1,0] neg_lo:[0,1] neg_hi:[0,1]
  v_pk_add_f32 v[34:35], v[34:35], v[14:15] op_sel_hi:[1,0] neg_lo:[0,1] neg_hi:[0,1]
  v_pk_add_f32 v[36:37], v[36:37], v[14:15] op_sel_hi:[1,0] neg_lo:[0,1] neg_hi:[0,1]
  v_pk_add_f32 v[38:39], v[38:39], v[14:15] op_sel_hi:[1,0] neg_lo:[0,1] neg_hi:[0,1]
  v_pk_add_f32 v[40:41], v[40:41], v[14:15] op_sel_hi:[1,0] neg_lo:[0,1] neg_hi:[0,1]
  v_pk_add_f32 v[42:43], v[42:43], v[14:15] op_sel_hi:[1,0] neg_lo:[0,1] neg_hi:[0,1]
  v_pk_add_f32 v[44:45], v[44:45], v[14:15] op_sel_hi:[1,0] neg_lo:[0,1] neg_hi:[0,1]
  v_pk_add_f32 v[46:47], v[46:47], v[14:15] op_sel_hi:[1,0] neg_lo:[0,1] neg_hi:[0,1]
  v_pk_add_f32 v[48:49], v[48:49], v[14:15] op_sel_hi:[1,0] neg_lo:[0,1] neg_hi:[0,1]
  v_pk_add_f32 v[50:51], v[50:51], v[14:15] op_sel_hi:[1,0] neg_lo:[0,1] neg_hi:[0,1]
  v_pk_mul_f32 v[10:11], v[32:33], v[32:33]
  v_pk_fma_f32 v[10:11], v[34:35], v[34:35], v[10:11]
  v_pk_fma_f32 v[10:11], v[36:37], v[36:37], v[10:11]
  v_pk_fma_f32 v[10:11], v[38:39], v[38:39], v[10:11]
  v_pk_fma_f32 v[10:11], v[40:41], v[40:41], v[10:11]
  v_pk_fma_f32 v[10:11], v[42:43], v[42:43], v[10:11]
  v_pk_fma_f32 v[10:11], v[44:45], v[44:45], v[10:11]
  v_pk_fma_f32 v[10:11], v[46:47], v[46:47], v[10:11]
  v_pk_fma_f32 v[10:11], v[48:49], v[48:49], v[10:11]
  v_pk_fma_f32 v[10:11], v[50:51], v[50:51], v[10:11]
  v_add_f32 v12, v10, v11
  s_nop 1
  v_add_f32_dpp v12, v12, v12 row_ror:8 row_mask:0xf bank_mask:0xf
  s_nop 1
  v_add_f32_dpp v12, v12, v12 row_ror:4 row_mask:0xf bank_mask:0xf
  s_nop 1
  v_add_f32_dpp v12, v12, v12 row_ror:2 row_mask:0xf bank_mask:0xf
  s_nop 1
  v_add_f32_dpp v12, v12, v12 row_ror:1 row_mask:0xf bank_mask:0xf
  v_mov_b32 v10, v12
  s_nop 1
  v_permlane16_swap_b32 v12, v10
  v_add_f32 v12, v12, v10
  v_mul_f32 v12, 0x3acccccd, v12
  v_add_f32 v10, 0x3727c5ac, v12
  v_rsq_f32 v15, v10
  s_nop 0
  v_mul_f32 v10, v15, v15
  v_mul_f32 v10, v10, v12
  v_add_f32 v10, 0x3727c5ac, v10
  v_rsq_f32 v10, v10
  s_nop 0
  v_mul_f32 v16, v15, v10
  v_pk_mul_f32 v[32:33], v[32:33], v[16:17] op_sel_hi:[1,0]
  v_pk_mul_f32 v[34:35], v[34:35], v[16:17] op_sel_hi:[1,0]
  v_pk_mul_f32 v[36:37], v[36:37], v[16:17] op_sel_hi:[1,0]
  v_pk_mul_f32 v[38:39], v[38:39], v[16:17] op_sel_hi:[1,0]
  v_pk_mul_f32 v[40:41], v[40:41], v[16:17] op_sel_hi:[1,0]
  v_pk_mul_f32 v[42:43], v[42:43], v[16:17] op_sel_hi:[1,0]
  v_pk_mul_f32 v[44:45], v[44:45], v[16:17] op_sel_hi:[1,0]
  v_pk_mul_f32 v[46:47], v[46:47], v[16:17] op_sel_hi:[1,0]
  v_pk_mul_f32 v[48:49], v[48:49], v[16:17] op_sel_hi:[1,0]
  v_pk_mul_f32 v[50:51], v[50:51], v[16:17] op_sel_hi:[1,0]
  v_cvt_pk_bf16_f32 v22, v32, v33
  v_cvt_pk_bf16_f32 v23, v34, v35
  v_cvt_pk_bf16_f32 v24, v36, v37
  v_cvt_pk_bf16_f32 v25, v38, v39
  v_cvt_pk_bf16_f32 v26, v40, v41
  v_cvt_pk_bf16_f32 v27, v42, v43
  v_cvt_pk_bf16_f32 v28, v44, v45
  v_cvt_pk_bf16_f32 v29, v46, v47
  v_cvt_pk_bf16_f32 v30, v48, v49
  v_cvt_pk_bf16_f32 v31, v50, v51
  ds_write_b64 v64, v[22:23] offset:0
  ds_write_b64 v64, v[24:25] offset:256
  ds_write_b64 v64, v[26:27] offset:512
  ds_write_b64 v64, v[28:29] offset:768
  ds_write_b64 v64, v[30:31] offset:1024
  s_mov_b32 s4, 1
  s_mov_b32 s5, 1
  s_mov_b64 exec, s[4:5]
  ds_write_b64 v65, v[14:15]
  s_mov_b64 exec, -1
  s_waitcnt lgkmcnt(0)
  s_barrier
  s_cmp_ge_u32 s40, 4
  s_cbranch_scc1 LB_loader
  ds_read_b64_tr_b16 v[36:37], v66 offset:0
  ds_read_b64_tr_b16 v[38:39], v66 offset:5248
  ds_read_b64_tr_b16 v[40:41], v66 offset:256
  ds_read_b64_tr_b16 v[42:43], v66 offset:5504
  ds_read_b64_tr_b16 v[44:45], v66 offset:512
  ds_read_b64_tr_b16 v[46:47], v66 offset:5760
  ds_read_b64_tr_b16 v[48:49], v66 offset:768
  ds_read_b64_tr_b16 v[50:51], v66 offset:6016
  ds_read_b64_tr_b16 v[52:53], v66 offset:1024
  ds_read_b64_tr_b16 v[54:55], v66 offset:6272
  s_waitcnt lgkmcnt(8)
  buffer_store_dwordx4 v[36:39], v67, s[64:67], s6 offen sc1
  s_add_u32 s6, s6, 524288
  s_waitcnt lgkmcnt(6)
  buffer_store_dwordx4 v[40:43], v67, s[64:67], s6 offen sc1
  s_add_u32 s6, s6, 524288
  s_waitcnt lgkmcnt(4)
  buffer_store_dwordx4 v[44:47], v67, s[64:67], s6 offen sc1
  s_add_u32 s6, s6, 524288
  s_waitcnt lgkmcnt(2)
  buffer_store_dwordx4 v[48:51], v67, s[64:67], s6 offen sc1
  s_add_u32 s6, s6, 524288
  s_waitcnt lgkmcnt(0)
  buffer_store_dwordx4 v[52:55], v67, s[64:67], s6 offen sc1
  s_cmp_lg_u32 s40, 0
  s_cbranch_scc1 Lst_4
  v_lshlrev_b32 v2, 4, v1
  v_add_u32 v3, 154112, v2
  s_mov_b64 exec, 0xff
  ds_read_b128 v[56:59], v3
  s_lshl_b32 s44, s39, 7
  s_waitcnt lgkmcnt(0)
  buffer_store_dwordx4 v[56:59], v2, s[68:71], s44 offen sc1
  s_mov_b64 exec, -1
Lst_4:
  s_cmp_lg_u32 s39, 0
  s_cbranch_scc1 LB_nozero
  s_cmp_lg_u32 s40, 1
  s_cbranch_scc1 LB_nozero
  v_lshlrev_b32 v2, 7, v1
  v_mov_b32 v3, 0
  buffer_store_dword v3, v2, s[12:15], 0 offen sc1
LB_nozero:
  s_mov_b32 s76, s26
  s_mov_b32 s77, s27
  s_mov_b32 s78, 3456
  s_mov_b32 s79, 0x20000
  s_add_u32 s88, s36, 2629632
  s_addc_u32 s89, s37, 0
  s_mov_b32 s90, 2211840
  s_mov_b32 s91, 0x20000
  s_and_b32 s44, s40, 1
  s_lshl_b32 s44, s44, 1
  s_lshr_b32 s45, s40, 1
  s_add_u32 s44, s44, s45
  s_lshl_b32 s45, s43, 2
  s_add_u32 s55, s44, s45
  s_lshl_b32 s44, s55, 6
  v_lshrrev_b32 v2, 4, v1
  v_lshl_add_u32 v2, v2, 3, s44
  buffer_load_dwordx2 v[14:15], v2, s[76:79], 0 offen
  buffer_load_dwordx2 v[16:17], v2, s[76:79], 0 offen offset:32
  s_lshr_b32 s45, s40, 1
  s_lshl_b32 s44, s45, 10
  s_add_u32 s44, s44, 0
  v_lshl_add_u32 v5, v1, 4, s44
  v_and_b32 v2, 15, v1
  v_lshrrev_b32 v3, 4, v1
  v_lshrrev_b32 v4, 2, v2
  v_and_b32 v10, 1, v3
  v_lshl_or_b32 v10, v10, 2, v4
  s_and_b32 s44, s40, 1
  s_lshl_b32 s44, s44, 1
  s_add_u32 s44, s44, s45
  s_lshl_b32 s44, s44, 1
  v_xor_b32 v10, s44, v10
  v_lshlrev_b32 v10, 5, v10
  v_lshl_add_u32 v3, v3, 3, v4
  v_lshl_add_u32 v10, v3, 8, v10
  v_and_b32 v2, 3, v2
  v_lshl_add_u32 v10, v2, 3, v10
  v_xor_b32 v11, 32, v10
  v_xor_b32 v12, 64, v10
  v_xor_b32 v13, 96, v10
  s_lshl_b32 s44, s45, 13
  s_add_u32 s44, s44, 10240
  v_add_u32 v10, s44, v10
  v_add_u32 v11, s44, v11
  v_add_u32 v12, s44, v12
  v_add_u32 v13, s44, v13
  s_waitcnt vmcnt(0)
  v_mov_b32 v2, 163584
  v_mov_b32 v3, 1
  s_mov_b64 exec, 1
  ds_add_rtn_u32 v3, v2, v3
  s_waitcnt lgkmcnt(0)
  v_readfirstlane_b32 s3, v3
  s_mov_b64 exec, -1
  s_cmp_lg_u32 s3, 3
  s_cbranch_scc1 Lpub_5
  s_lshr_b32 s3, s39, 4
  s_lshr_b32 s59, s3, 1
  s_lshl_b32 s59, s59, 6
  s_and_b32 s3, s3, 1
  s_lshl_b32 s3, s3, 2
  s_add_u32 s59, s59, s3
  s_mov_b64 exec, 1
  v_mov_b32 v2, s59
  v_mov_b32 v3, 1
  buffer_atomic_add v3, v2, s[8:11], 0 offen sc1
  s_mov_b64 exec, -1
Lpub_5:
  s_cmp_ge_u32 s39, 112
  s_cbranch_scc1 L_c_p4
  v_mov_b64 v[104:105], 0
  v_mov_b64 v[106:107], 0
  v_mov_b64 v[108:109], 0
  v_mov_b64 v[110:111], 0
  v_mov_b64 v[112:113], 0
  v_mov_b64 v[114:115], 0
  v_mov_b64 v[116:117], 0
  v_mov_b64 v[118:119], 0
  v_mov_b64 v[120:121], 0
  v_mov_b64 v[122:123], 0
  v_mov_b64 v[124:125], 0
  v_mov_b64 v[126:127], 0
  v_mov_b64 v[128:129], 0
  v_mov_b64 v[130:131], 0
  v_mov_b64 v[132:133], 0
  v_mov_b64 v[134:135], 0
  v_mov_b64 v[136:137], 0
  v_mov_b64 v[138:139], 0
  v_mov_b64 v[140:141], 0
  v_mov_b64 v[142:143], 0
  s_waitcnt vmcnt(0)
  v_lshlrev_b32 v144, 16, v14
  v_and_b32 v145, 0xffff0000, v14
  v_lshlrev_b32 v146, 16, v15
  v_and_b32 v147, 0xffff0000, v15
  v_lshlrev_b32 v148, 16, v16
  v_and_b32 v149, 0xffff0000, v16
  v_lshlrev_b32 v150, 16, v17
  v_and_b32 v151, 0xffff0000, v17
  v_mov_b64 v[64:65], v[144:145]
  v_mov_b64 v[66:67], v[146:147]
  v_mov_b64 v[68:69], v[144:145]
  v_mov_b64 v[70:71], v[146:147]
  v_mov_b64 v[72:73], v[144:145]
  v_mov_b64 v[74:75], v[146:147]
  v_mov_b64 v[76:77], v[144:145]
  v_mov_b64 v[78:79], v[146:147]
  v_mov_b64 v[80:81], v[144:145]
  v_mov_b64 v[82:83], v[146:147]
  v_mov_b64 v[84:85], v[148:149]
  v_mov_b64 v[86:87], v[150:151]
  v_mov_b64 v[88:89], v[148:149]
  v_mov_b64 v[90:91], v[150:151]
  v_mov_b64 v[92:93], v[148:149]
  v_mov_b64 v[94:95], v[150:151]
  v_mov_b64 v[96:97], v[148:149]
  v_mov_b64 v[98:99], v[150:151]
  v_mov_b64 v[100:101], v[148:149]
  v_mov_b64 v[102:103], v[150:151]
  s_mul_i32 s57, s42, 270
  s_add_u32 s57, s57, s55
  s_lshl_b32 s57, s57, 10
  s_mov_b32 s58, s55
  s_lshl_b32 s4, s42, 7
  s_add_u32 s4, s4, 2048
  s_mul_i32 s44, s40, 10240
  s_add_u32 s44, s44, 118784
  v_lshl_add_u32 v176, v1, 4, s44
  s_xor_b32 s44, s40, 2
  s_mul_i32 s44, s44, 10240
  s_add_u32 s44, s44, 118784
  v_lshl_add_u32 v177, v1, 4, s44
  s_and_b32 s44, s2, 7
  s_lshr_b32 s45, s2, 3
  s_and_b32 s42, s44, 1
  s_lshl_b32 s42, s42, 2
  s_and_b32 s46, s45, 3
  s_add_u32 s42, s42, s46
  s_lshr_b32 s43, s44, 1
  s_lshl_b32 s43, s43, 3
  s_lshr_b32 s45, s45, 2
  s_add_u32 s43, s43, s45
  s_mul_i32 s44, s46, 0
  s_add_u32 s44, s44, s45
  s_cmp_ge_u32 s44, 10
  s_cselect_b32 s56, 10, 0
  s_sub_u32 s56, s44, s56
  s_mul_i32 s46, s46, 7
  s_mul_i32 s45, s45, 0
  s_add_u32 s45, s45, s46
  s_mul_i32 s44, s45, 2428
  s_lshr_b32 s44, s44, 16
  s_mul_i32 s44, s44, 27
  s_sub_u32 s38, s45, s44
  s_mov_b32 s76, s32
  s_mov_b32 s77, s33
  s_mov_b32 s78, 2621440
  s_mov_b32 s79, 0x20000
  s_mov_b32 s80, s16
  s_mov_b32 s81, s17
  s_mov_b32 s82, 2621440
  s_mov_b32 s83, 0x20000
  s_mov_b32 s84, s30
  s_mov_b32 s85, s31
  s_mov_b32 s86, 4096
  s_mov_b32 s87, 0x20000
  s_lshr_b32 s45, s40, 1
  s_and_b32 s44, s40, 1
  s_lshl_b32 s44, s44, 1
  s_add_u32 s55, s44, s45
  s_lshl_b32 s44, s45, 10
  s_add_u32 s44, s44, 10240
  v_lshl_add_u32 v2, v1, 3, s44
  s_lshl_b32 s44, s55, 11
  v_add_u32 v156, s44, v2
  s_xor_b32 s44, s55, 1
  s_lshl_b32 s44, s44, 11
  v_add_u32 v157, s44, v2
  s_lshl_b32 s44, s45, 10
  s_add_u32 s44, s44, 73728
  v_lshl_add_u32 v152, v1, 4, s44
  v_and_b32 v2, 15, v1
  v_lshrrev_b32 v3, 4, v1
  v_lshrrev_b32 v4, 2, v2
  v_lshl_add_u32 v3, v3, 2, v4
  v_and_b32 v2, 3, v2
  v_mul_u32_u24 v155, 160, v3
  v_lshl_add_u32 v155, v2, 3, v155
  s_mul_i32 s44, s45, 5120
  v_add_u32 v155, s44, v155
  v_bfe_u32 v153, v3, 1, 2
  v_xor_b32 v153, s55, v153
  v_lshlrev_b32 v153, 5, v153
  v_lshl_add_u32 v153, v3, 7, v153
  v_lshl_add_u32 v153, v2, 3, v153
  v_xor_b32 v154, 32, v153
  s_lshl_b32 s44, s45, 12
  s_add_u32 s44, s44, 83968
  v_add_u32 v153, s44, v153
  v_add_u32 v154, s44, v154
  s_mul_i32 s44, s40, 5120
  s_add_u32 s44, s44, 0
  v_lshl_add_u32 v174, v1, 4, s44
  s_xor_b32 s44, s40, 2
  s_mul_i32 s44, s44, 5120
  s_add_u32 s44, s44, 0
  v_lshl_add_u32 v175, v1, 4, s44
  s_lshl_b32 s44, s43, 2
  s_add_u32 s44, s44, s55
  s_lshl_b32 s44, s44, 4
  v_and_b32 v2, 15, v1
  v_add_u32 v2, s44, v2
  v_lshlrev_b32 v3, 1, v2
  buffer_load_ushort v158, v3, s[84:87], 0 offen
  v_mul_u32_u24 v2, 1280, v2
  v_lshrrev_b32 v3, 4, v1
  v_lshl_add_u32 v160, v3, 3, v2
  s_mul_i32 s59, s42, 160
  buffer_load_dwordx2 v[162:163], v160, s[80:83], s59 offen offset:0
  buffer_load_dwordx2 v[164:165], v160, s[80:83], s59 offen offset:32
  buffer_load_dwordx2 v[166:167], v160, s[80:83], s59 offen offset:64
  buffer_load_dwordx2 v[168:169], v160, s[80:83], s59 offen offset:96
  buffer_load_dwordx2 v[170:171], v160, s[80:83], s59 offen offset:128
  s_cmp_lg_u32 s40, 0
  s_cbranch_scc1 Lcp_6
  s_lshr_b32 s3, s23, 2
  s_add_u32 s3, s3, 0
  s_and_b32 s3, s3, 7
  s_lshr_b32 s6, s3, 1
  s_lshl_b32 s6, s6, 6
  s_and_b32 s3, s3, 1
  s_lshl_b32 s3, s3, 2
  s_add_u32 s6, s6, s3
  s_lshr_b32 s3, s23, 2
  s_add_u32 s3, s3, 1
  s_and_b32 s3, s3, 7
  s_lshr_b32 s7, s3, 1
  s_lshl_b32 s7, s7, 6
  s_and_b32 s3, s3, 1
  s_lshl_b32 s3, s3, 2
  s_add_u32 s7, s7, s3
  s_mov_b32 s3, 262144
  v_mov_b32 v2, 0
  v_mov_b32 v3, 0
  v_writelane_b32 v2, s6, 0
  s_mov_b32 vcc_lo, 16
  v_writelane_b32 v3, vcc_lo, 0
  v_writelane_b32 v2, s7, 1
  s_mov_b32 vcc_lo, 16
  v_writelane_b32 v3, vcc_lo, 1
LpollS1c_7:
  s_mov_b64 exec, 3
  buffer_load_dword v4, v2, s[8:11], 0 offen sc1
  s_mov_b64 exec, 3
  s_waitcnt vmcnt(0)
  v_cmp_lt_u32 vcc, v4, v3
  s_nop 3
  s_cmp_eq_u64 vcc, 0
  s_cbranch_scc1 LpolldS1c_8
  s_sleep 4
  s_sub_u32 s3, s3, 1
  s_cmp_lg_u32 s3, 0
  s_cbranch_scc1 LpollS1c_7
LpolldS1c_8:
  s_mov_b64 exec, -1
  v_mov_b32 v2, 163592
  v_mov_b32 v3, 1
  s_mov_b64 exec, 1
  ds_write_b32 v2, v3
  s_mov_b64 exec, -1
  s_mov_b32 s3, 262144
  v_mov_b32 v2, 0
  v_mov_b32 v3, 0
  s_mov_b32 vcc_lo, 0
  v_writelane_b32 v2, vcc_lo, 0
  s_mov_b32 vcc_lo, 16
  v_writelane_b32 v3, vcc_lo, 0
  s_mov_b32 vcc_lo, 4
  v_writelane_b32 v2, vcc_lo, 1
  s_mov_b32 vcc_lo, 16
  v_writelane_b32 v3, vcc_lo, 1
  s_mov_b32 vcc_lo, 64
  v_writelane_b32 v2, vcc_lo, 2
  s_mov_b32 vcc_lo, 16
  v_writelane_b32 v3, vcc_lo, 2
  s_mov_b32 vcc_lo, 68
  v_writelane_b32 v2, vcc_lo, 3
  s_mov_b32 vcc_lo, 16
  v_writelane_b32 v3, vcc_lo, 3
  s_mov_b32 vcc_lo, 128
  v_writelane_b32 v2, vcc_lo, 4
  s_mov_b32 vcc_lo, 16
  v_writelane_b32 v3, vcc_lo, 4
  s_mov_b32 vcc_lo, 132
  v_writelane_b32 v2, vcc_lo, 5
  s_mov_b32 vcc_lo, 16
  v_writelane_b32 v3, vcc_lo, 5
  s_mov_b32 vcc_lo, 192
  v_writelane_b32 v2, vcc_lo, 6
  s_mov_b32 vcc_lo, 16
  v_writelane_b32 v3, vcc_lo, 6
  s_mov_b32 vcc_lo, 196
  v_writelane_b32 v2, vcc_lo, 7
  s_mov_b32 vcc_lo, 16
  v_writelane_b32 v3, vcc_lo, 7
LpollS1d_9:
  s_mov_b64 exec, 255
  buffer_load_dword v4, v2, s[8:11], 0 offen sc1
  s_mov_b64 exec, 255
  s_waitcnt vmcnt(0)
  v_cmp_lt_u32 vcc, v4, v3
  s_nop 3
  s_cmp_eq_u64 vcc, 0
  s_cbranch_scc1 LpolldS1d_10
  s_sleep 8
  s_sub_u32 s3, s3, 1
  s_cmp_lg_u32 s3, 0
  s_cbranch_scc1 LpollS1d_9
LpolldS1d_10:
  s_mov_b64 exec, -1
  v_mov_b32 v2, 163604
  v_mov_b32 v3, 1
  s_mov_b64 exec, 1
  ds_write_b32 v2, v3
  s_mov_b64 exec, -1
Lcp_6:
  s_mov_b32 s48, 0
  s_mov_b32 s47, 16
  s_barrier
  ds_read_b128 a[16:19], v5 offset:0
  ds_read_b64_tr_b16 a[0:1], v10 offset:0
  ds_read_b64_tr_b16 a[2:3], v10 offset:1024
  ds_read_b64_tr_b16 a[4:5], v11 offset:0
  ds_read_b64_tr_b16 a[6:7], v11 offset:1024
  ds_read_b64_tr_b16 a[8:9], v12 offset:0
  ds_read_b64_tr_b16 a[10:11], v12 offset:1024
  ds_read_b64_tr_b16 a[12:13], v13 offset:0
  ds_read_b64_tr_b16 a[14:15], v13 offset:1024
  ds_read_b128 a[20:23], v5 offset:2048
  ds_read_b128 a[24:27], v5 offset:4096
  ds_read_b128 a[28:31], v5 offset:6144
  ds_read_b128 a[32:35], v5 offset:8192
  s_mov_b32 s54, 26624
  s_add_u32 s48, s48, 1
  s_cmp_eq_u32 s48, 6
  s_cselect_b32 s54, 4294834176, s54
  s_cselect_b32 s48, 0, s48
  v_add_u32 v5, s54, v5
  v_add_u32 v10, s54, v10
  v_add_u32 v11, s54, v11
  v_add_u32 v12, s54, v12
  v_add_u32 v13, s54, v13
  s_waitcnt lgkmcnt(0)
Lc_11:
  s_barrier
  v_mfma_f32_16x16x32_bf16 v[64:67], a[0:3], a[16:19], v[64:67]
  ds_read_b128 a[52:55], v5 offset:0
  ds_read_b64_tr_b16 a[36:37], v10 offset:0
  v_mfma_f32_16x16x32_bf16 v[84:87], a[4:7], a[16:19], v[84:87]
  ds_read_b64_tr_b16 a[38:39], v10 offset:1024
  ds_read_b64_tr_b16 a[40:41], v11 offset:0
  v_mfma_f32_16x16x32_bf16 v[104:107], a[8:11], a[16:19], v[104:107]
  ds_read_b64_tr_b16 a[42:43], v11 offset:1024
  ds_read_b64_tr_b16 a[44:45], v12 offset:0
  v_mfma_f32_16x16x32_bf16 v[124:127], a[12:15], a[16:19], v[124:127]
  ds_read_b64_tr_b16 a[46:47], v12 offset:1024
  ds_read_b64_tr_b16 a[48:49], v13 offset:0
  v_mfma_f32_16x16x32_bf16 v[68:71], a[0:3], a[20:23], v[68:71]
  ds_read_b64_tr_b16 a[50:51], v13 offset:1024
  ds_read_b128 a[56:59], v5 offset:2048
  v_mfma_f32_16x16x32_bf16 v[88:91], a[4:7], a[20:23], v[88:91]
  ds_read_b128 a[60:63], v5 offset:4096
  ds_read_b128 a[64:67], v5 offset:6144
  v_mfma_f32_16x16x32_bf16 v[108:111], a[8:11], a[20:23], v[108:111]
  ds_read_b128 a[68:71], v5 offset:8192
  s_mov_b32 s54, 26624
  s_add_u32 s48, s48, 1
  s_cmp_eq_u32 s48, 6
  s_cselect_b32 s54, 4294834176, s54
  s_cselect_b32 s48, 0, s48
  v_add_u32 v5, s54, v5
  v_mfma_f32_16x16x32_bf16 v[128:131], a[12:15], a[20:23], v[128:131]
  v_add_u32 v10, s54, v10
  v_add_u32 v11, s54, v11
  v_mfma_f32_16x16x32_bf16 v[72:75], a[0:3], a[24:27], v[72:75]
  v_add_u32 v12, s54, v12
  v_add_u32 v13, s54, v13
  v_mfma_f32_16x16x32_bf16 v[92:95], a[4:7], a[24:27], v[92:95]
  v_mfma_f32_16x16x32_bf16 v[112:115], a[8:11], a[24:27], v[112:115]
  v_mfma_f32_16x16x32_bf16 v[132:135], a[12:15], a[24:27], v[132:135]
  v_mfma_f32_16x16x32_bf16 v[76:79], a[0:3], a[28:31], v[76:79]
  v_mfma_f32_16x16x32_bf16 v[96:99], a[4:7], a[28:31], v[96:99]
  v_mfma_f32_16x16x32_bf16 v[116:119], a[8:11], a[28:31], v[116:119]
  v_mfma_f32_16x16x32_bf16 v[136:139], a[12:15], a[28:31], v[136:139]
  v_mfma_f32_16x16x32_bf16 v[80:83], a[0:3], a[32:35], v[80:83]
  v_mfma_f32_16x16x32_bf16 v[100:103], a[4:7], a[32:35], v[100:103]
  v_mfma_f32_16x16x32_bf16 v[120:123], a[8:11], a[32:35], v[120:123]
  v_mfma_f32_16x16x32_bf16 v[140:143], a[12:15], a[32:35], v[140:143]
  s_waitcnt lgkmcnt(0)
  s_barrier
  v_mfma_f32_16x16x32_bf16 v[64:67], a[36:39], a[52:55], v[64:67]
  ds_read_b128 a[16:19], v5 offset:0
  ds_read_b64_tr_b16 a[0:1], v10 offset:0
  v_mfma_f32_16x16x32_bf16 v[84:87], a[40:43], a[52:55], v[84:87]
  ds_read_b64_tr_b16 a[2:3], v10 offset:1024
  ds_read_b64_tr_b16 a[4:5], v11 offset:0
  v_mfma_f32_16x16x32_bf16 v[104:107], a[44:47], a[52:55], v[104:107]
  ds_read_b64_tr_b16 a[6:7], v11 offset:1024
  ds_read_b64_tr_b16 a[8:9], v12 offset:0
  v_mfma_f32_16x16x32_bf16 v[124:127], a[48:51], a[52:55], v[124:127]
  ds_read_b64_tr_b16 a[10:11], v12 offset:1024
  ds_read_b64_tr_b16 a[12:13], v13 offset:0
  v_mfma_f32_16x16x32_bf16 v[68:71], a[36:39], a[56:59], v[68:71]
  ds_read_b64_tr_b16 a[14:15], v13 offset:1024
  ds_read_b128 a[20:23], v5 offset:2048
  v_mfma_f32_16x16x32_bf16 v[88:91], a[40:43], a[56:59], v[88:91]
  ds_read_b128 a[24:27], v5 offset:4096
  ds_read_b128 a[28:31], v5 offset:6144
  v_mfma_f32_16x16x32_bf16 v[108:111], a[44:47], a[56:59], v[108:111]
  ds_read_b128 a[32:35], v5 offset:8192
  s_mov_b32 s54, 26624
  s_add_u32 s48, s48, 1
  s_cmp_eq_u32 s48, 6
  s_cselect_b32 s54, 4294834176, s54
  s_cselect_b32 s48, 0, s48
  v_add_u32 v5, s54, v5
  v_mfma_f32_16x16x32_bf16 v[128:131], a[48:51], a[56:59], v[128:131]
  v_add_u32 v10, s54, v10
  v_add_u32 v11, s54, v11
  v_mfma_f32_16x16x32_bf16 v[72:75], a[36:39], a[60:63], v[72:75]
  v_add_u32 v12, s54, v12
  v_add_u32 v13, s54, v13
  v_mfma_f32_16x16x32_bf16 v[92:95], a[40:43], a[60:63], v[92:95]
  v_mfma_f32_16x16x32_bf16 v[112:115], a[44:47], a[60:63], v[112:115]
  v_mfma_f32_16x16x32_bf16 v[132:135], a[48:51], a[60:63], v[132:135]
  v_mfma_f32_16x16x32_bf16 v[76:79], a[36:39], a[64:67], v[76:79]
  v_mfma_f32_16x16x32_bf16 v[96:99], a[40:43], a[64:67], v[96:99]
  v_mfma_f32_16x16x32_bf16 v[116:119], a[44:47], a[64:67], v[116:119]
  v_mfma_f32_16x16x32_bf16 v[136:139], a[48:51], a[64:67], v[136:139]
  v_mfma_f32_16x16x32_bf16 v[80:83], a[36:39], a[68:71], v[80:83]
  v_mfma_f32_16x16x32_bf16 v[100:103], a[40:43], a[68:71], v[100:103]
  v_mfma_f32_16x16x32_bf16 v[120:123], a[44:47], a[68:71], v[120:123]
  v_mfma_f32_16x16x32_bf16 v[140:143], a[48:51], a[68:71], v[140:143]
  s_sub_u32 s47, s47, 1
  s_cmp_lg_u32 s47, 0
  s_waitcnt lgkmcnt(0)
  s_cbranch_scc1 Lc_11
  s_waitcnt lgkmcnt(0)
  s_nop 7
  ds_write_b128 v176, v[104:107] offset:0
  ds_write_b128 v176, v[124:127] offset:1024
  ds_write_b128 v176, v[108:111] offset:2048
  ds_write_b128 v176, v[128:131] offset:3072
  ds_write_b128 v176, v[112:115] offset:4096
  ds_write_b128 v176, v[132:135] offset:5120
  ds_write_b128 v176, v[116:119] offset:6144
  ds_write_b128 v176, v[136:139] offset:7168
  ds_write_b128 v176, v[120:123] offset:8192
  ds_write_b128 v176, v[140:143] offset:9216
  s_waitcnt lgkmcnt(0)
  s_lshl_b32 s44, s40, 2
  s_add_u32 s44, s44, 163616
  v_mov_b32 v2, s44
  s_xor_b32 s44, s44, 8
  v_mov_b32 v4, 1
  ds_write_b32 v2, v4
  v_mov_b32 v2, s44
Lkf_12:
  ds_read_b32 v4, v2
  s_waitcnt lgkmcnt(0)
  v_readfirstlane_b32 s45, v4
  s_nop 0
  s_cmp_eq_u32 s45, 0
  s_cbranch_scc1 Lkf_12
  ds_read_b128 v[104:107], v177 offset:0
  ds_read_b128 v[124:127], v177 offset:1024
  ds_read_b128 v[108:111], v177 offset:2048
  ds_read_b128 v[128:131], v177 offset:3072
  ds_read_b128 v[112:115], v177 offset:4096
  ds_read_b128 v[132:135], v177 offset:5120
  ds_read_b128 v[116:119], v177 offset:6144
  ds_read_b128 v[136:139], v177 offset:7168
  ds_read_b128 v[120:123], v177 offset:8192
  ds_read_b128 v[140:143], v177 offset:9216
  s_waitcnt lgkmcnt(9)
  v_pk_add_f32 v[64:65], v[64:65], v[104:105]
  v_pk_add_f32 v[66:67], v[66:67], v[106:107]
  s_waitcnt lgkmcnt(8)
  v_pk_add_f32 v[84:85], v[84:85], v[124:125]
  v_pk_add_f32 v[86:87], v[86:87], v[126:127]
  s_waitcnt lgkmcnt(7)
  v_pk_add_f32 v[68:69], v[68:69], v[108:109]
  v_pk_add_f32 v[70:71], v[70:71], v[110:111]
  s_waitcnt lgkmcnt(6)
  v_pk_add_f32 v[88:89], v[88:89], v[128:129]
  v_pk_add_f32 v[90:91], v[90:91], v[130:131]
  s_waitcnt lgkmcnt(5)
  v_pk_add_f32 v[72:73], v[72:73], v[112:113]
  v_pk_add_f32 v[74:75], v[74:75], v[114:115]
  s_waitcnt lgkmcnt(4)
  v_pk_add_f32 v[92:93], v[92:93], v[132:133]
  v_pk_add_f32 v[94:95], v[94:95], v[134:135]
  s_waitcnt lgkmcnt(3)
  v_pk_add_f32 v[76:77], v[76:77], v[116:117]
  v_pk_add_f32 v[78:79], v[78:79], v[118:119]
  s_waitcnt lgkmcnt(2)
  v_pk_add_f32 v[96:97], v[96:97], v[136:137]
  v_pk_add_f32 v[98:99], v[98:99], v[138:139]
  s_waitcnt lgkmcnt(1)
  v_pk_add_f32 v[80:81], v[80:81], v[120:121]
  v_pk_add_f32 v[82:83], v[82:83], v[122:123]
  s_waitcnt lgkmcnt(0)
  v_pk_add_f32 v[100:101], v[100:101], v[140:141]
  v_pk_add_f32 v[102:103], v[102:103], v[142:143]
  s_mov_b32 s62, 0xbdd2d3e8
  s_mov_b32 s63, 0xbdd2d3e8
  v_mov_b32 v32, 0xc0135761
  v_mov_b32 v33, 0xc0135761
  v_lshlrev_b32 v34, 4, v1
  s_cmp_ge_u32 s58, 54
  s_cbranch_scc1 Lg3skip_13
  v_pk_mul_f32 v[36:37], v[64:65], v[64:65]
  v_pk_mul_f32 v[38:39], v[66:67], v[66:67]
  v_pk_mul_f32 v[40:41], v[84:85], v[84:85]
  v_pk_mul_f32 v[42:43], v[86:87], v[86:87]
  v_pk_fma_f32 v[36:37], v[36:37], s[62:63], v[32:33]
  v_pk_fma_f32 v[38:39], v[38:39], s[62:63], v[32:33]
  v_pk_fma_f32 v[40:41], v[40:41], s[62:63], v[32:33]
  v_pk_fma_f32 v[42:43], v[42:43], s[62:63], v[32:33]
  v_pk_mul_f32 v[36:37], v[36:37], v[64:65]
  v_pk_mul_f32 v[38:39], v[38:39], v[66:67]
  v_pk_mul_f32 v[40:41], v[40:41], v[84:85]
  v_pk_mul_f32 v[42:43], v[42:43], v[86:87]
  v_exp_f32 v36, v36
  v_exp_f32 v38, v38
  v_exp_f32 v40, v40
  v_exp_f32 v42, v42
  v_exp_f32 v37, v37
  v_exp_f32 v39, v39
  v_exp_f32 v41, v41
  v_exp_f32 v43, v43
  v_pk_add_f32 v[36:37], v[36:37], 1.0 op_sel_hi:[1,0]
  v_pk_add_f32 v[38:39], v[38:39], 1.0 op_sel_hi:[1,0]
  v_pk_add_f32 v[40:41], v[40:41], 1.0 op_sel_hi:[1,0]
  v_pk_add_f32 v[42:43], v[42:43], 1.0 op_sel_hi:[1,0]
  v_rcp_f32 v36, v36
  v_rcp_f32 v38, v38
  v_rcp_f32 v40, v40
  v_rcp_f32 v42, v42
  v_rcp_f32 v37, v37
  v_rcp_f32 v39, v39
  v_rcp_f32 v41, v41
  v_rcp_f32 v43, v43
  v_pk_mul_f32 v[64:65], v[64:65], v[36:37]
  v_pk_mul_f32 v[66:67], v[66:67], v[38:39]
  v_pk_mul_f32 v[84:85], v[84:85], v[40:41]
  v_pk_mul_f32 v[86:87], v[86:87], v[42:43]
  v_cvt_pk_bf16_f32 v44, v64, v65
  v_cvt_pk_bf16_f32 v45, v66, v67
  v_cvt_pk_bf16_f32 v46, v84, v85
  v_cvt_pk_bf16_f32 v47, v86, v87
  buffer_store_dwordx4 v[44:47], v34, s[88:91], s57 offen sc1
  s_add_u32 s57, s57, 55296
  v_pk_mul_f32 v[36:37], v[68:69], v[68:69]
  v_pk_mul_f32 v[38:39], v[70:71], v[70:71]
  v_pk_mul_f32 v[40:41], v[88:89], v[88:89]
  v_pk_mul_f32 v[42:43], v[90:91], v[90:91]
  v_pk_fma_f32 v[36:37], v[36:37], s[62:63], v[32:33]
  v_pk_fma_f32 v[38:39], v[38:39], s[62:63], v[32:33]
  v_pk_fma_f32 v[40:41], v[40:41], s[62:63], v[32:33]
  v_pk_fma_f32 v[42:43], v[42:43], s[62:63], v[32:33]
  v_pk_mul_f32 v[36:37], v[36:37], v[68:69]
  v_pk_mul_f32 v[38:39], v[38:39], v[70:71]
  v_pk_mul_f32 v[40:41], v[40:41], v[88:89]
  v_pk_mul_f32 v[42:43], v[42:43], v[90:91]
  v_exp_f32 v36, v36
  v_exp_f32 v38, v38
  v_exp_f32 v40, v40
  v_exp_f32 v42, v42
  v_exp_f32 v37, v37
  v_exp_f32 v39, v39
  v_exp_f32 v41, v41
  v_exp_f32 v43, v43
  v_pk_add_f32 v[36:37], v[36:37], 1.0 op_sel_hi:[1,0]
  v_pk_add_f32 v[38:39], v[38:39], 1.0 op_sel_hi:[1,0]
  v_pk_add_f32 v[40:41], v[40:41], 1.0 op_sel_hi:[1,0]
  v_pk_add_f32 v[42:43], v[42:43], 1.0 op_sel_hi:[1,0]
  v_rcp_f32 v36, v36
  v_rcp_f32 v38, v38
  v_rcp_f32 v40, v40
  v_rcp_f32 v42, v42
  v_rcp_f32 v37, v37
  v_rcp_f32 v39, v39
  v_rcp_f32 v41, v41
  v_rcp_f32 v43, v43
  v_pk_mul_f32 v[68:69], v[68:69], v[36:37]
  v_pk_mul_f32 v[70:71], v[70:71], v[38:39]
  v_pk_mul_f32 v[88:89], v[88:89], v[40:41]
  v_pk_mul_f32 v[90:91], v[90:91], v[42:43]
  v_cvt_pk_bf16_f32 v48, v68, v69
  v_cvt_pk_bf16_f32 v49, v70, v71
  v_cvt_pk_bf16_f32 v50, v88, v89
  v_cvt_pk_bf16_f32 v51, v90, v91
  buffer_store_dwordx4 v[48:51], v34, s[88:91], s57 offen sc1
  s_add_u32 s57, s57, 55296
  v_pk_mul_f32 v[36:37], v[72:73], v[72:73]
  v_pk_mul_f32 v[38:39], v[74:75], v[74:75]
  v_pk_mul_f32 v[40:41], v[92:93], v[92:93]
  v_pk_mul_f32 v[42:43], v[94:95], v[94:95]
  v_pk_fma_f32 v[36:37], v[36:37], s[62:63], v[32:33]
  v_pk_fma_f32 v[38:39], v[38:39], s[62:63], v[32:33]
  v_pk_fma_f32 v[40:41], v[40:41], s[62:63], v[32:33]
  v_pk_fma_f32 v[42:43], v[42:43], s[62:63], v[32:33]
  v_pk_mul_f32 v[36:37], v[36:37], v[72:73]
  v_pk_mul_f32 v[38:39], v[38:39], v[74:75]
  v_pk_mul_f32 v[40:41], v[40:41], v[92:93]
  v_pk_mul_f32 v[42:43], v[42:43], v[94:95]
  v_exp_f32 v36, v36
  v_exp_f32 v38, v38
  v_exp_f32 v40, v40
  v_exp_f32 v42, v42
  v_exp_f32 v37, v37
  v_exp_f32 v39, v39
  v_exp_f32 v41, v41
  v_exp_f32 v43, v43
  v_pk_add_f32 v[36:37], v[36:37], 1.0 op_sel_hi:[1,0]
  v_pk_add_f32 v[38:39], v[38:39], 1.0 op_sel_hi:[1,0]
  v_pk_add_f32 v[40:41], v[40:41], 1.0 op_sel_hi:[1,0]
  v_pk_add_f32 v[42:43], v[42:43], 1.0 op_sel_hi:[1,0]
  v_rcp_f32 v36, v36
  v_rcp_f32 v38, v38
  v_rcp_f32 v40, v40
  v_rcp_f32 v42, v42
  v_rcp_f32 v37, v37
  v_rcp_f32 v39, v39
  v_rcp_f32 v41, v41
  v_rcp_f32 v43, v43
  v_pk_mul_f32 v[72:73], v[72:73], v[36:37]
  v_pk_mul_f32 v[74:75], v[74:75], v[38:39]
  v_pk_mul_f32 v[92:93], v[92:93], v[40:41]
  v_pk_mul_f32 v[94:95], v[94:95], v[42:43]
  v_cvt_pk_bf16_f32 v44, v72, v73
  v_cvt_pk_bf16_f32 v45, v74, v75
  v_cvt_pk_bf16_f32 v46, v92, v93
  v_cvt_pk_bf16_f32 v47, v94, v95
  buffer_store_dwordx4 v[44:47], v34, s[88:91], s57 offen sc1
  s_add_u32 s57, s57, 55296
  v_pk_mul_f32 v[36:37], v[76:77], v[76:77]
  v_pk_mul_f32 v[38:39], v[78:79], v[78:79]
  v_pk_mul_f32 v[40:41], v[96:97], v[96:97]
  v_pk_mul_f32 v[42:43], v[98:99], v[98:99]
  v_pk_fma_f32 v[36:37], v[36:37], s[62:63], v[32:33]
  v_pk_fma_f32 v[38:39], v[38:39], s[62:63], v[32:33]
  v_pk_fma_f32 v[40:41], v[40:41], s[62:63], v[32:33]
  v_pk_fma_f32 v[42:43], v[42:43], s[62:63], v[32:33]
  v_pk_mul_f32 v[36:37], v[36:37], v[76:77]
  v_pk_mul_f32 v[38:39], v[38:39], v[78:79]
  v_pk_mul_f32 v[40:41], v[40:41], v[96:97]
  v_pk_mul_f32 v[42:43], v[42:43], v[98:99]
  v_exp_f32 v36, v36
  v_exp_f32 v38, v38
  v_exp_f32 v40, v40
  v_exp_f32 v42, v42
  v_exp_f32 v37, v37
  v_exp_f32 v39, v39
  v_exp_f32 v41, v41
  v_exp_f32 v43, v43
  v_pk_add_f32 v[36:37], v[36:37], 1.0 op_sel_hi:[1,0]
  v_pk_add_f32 v[38:39], v[38:39], 1.0 op_sel_hi:[1,0]
  v_pk_add_f32 v[40:41], v[40:41], 1.0 op_sel_hi:[1,0]
  v_pk_add_f32 v[42:43], v[42:43], 1.0 op_sel_hi:[1,0]
  v_rcp_f32 v36, v36
  v_rcp_f32 v38, v38
  v_rcp_f32 v40, v40
  v_rcp_f32 v42, v42
  v_rcp_f32 v37, v37
  v_rcp_f32 v39, v39
  v_rcp_f32 v41, v41
  v_rcp_f32 v43, v43
  v_pk_mul_f32 v[76:77], v[76:77], v[36:37]
  v_pk_mul_f32 v[78:79], v[78:79], v[38:39]
  v_pk_mul_f32 v[96:97], v[96:97], v[40:41]
  v_pk_mul_f32 v[98:99], v[98:99], v[42:43]
  v_cvt_pk_bf16_f32 v48, v76, v77
  v_cvt_pk_bf16_f32 v49, v78, v79
  v_cvt_pk_bf16_f32 v50, v96, v97
  v_cvt_pk_bf16_f32 v51, v98, v99
  buffer_store_dwordx4 v[48:51], v34, s[88:91], s57 offen sc1
  s_add_u32 s57, s57, 55296
  v_pk_mul_f32 v[36:37], v[80:81], v[80:81]
  v_pk_mul_f32 v[38:39], v[82:83], v[82:83]
  v_pk_mul_f32 v[40:41], v[100:101], v[100:101]
  v_pk_mul_f32 v[42:43], v[102:103], v[102:103]
  v_pk_fma_f32 v[36:37], v[36:37], s[62:63], v[32:33]
  v_pk_fma_f32 v[38:39], v[38:39], s[62:63], v[32:33]
  v_pk_fma_f32 v[40:41], v[40:41], s[62:63], v[32:33]
  v_pk_fma_f32 v[42:43], v[42:43], s[62:63], v[32:33]
  v_pk_mul_f32 v[36:37], v[36:37], v[80:81]
  v_pk_mul_f32 v[38:39], v[38:39], v[82:83]
  v_pk_mul_f32 v[40:41], v[40:41], v[100:101]
  v_pk_mul_f32 v[42:43], v[42:43], v[102:103]
  v_exp_f32 v36, v36
  v_exp_f32 v38, v38
  v_exp_f32 v40, v40
  v_exp_f32 v42, v42
  v_exp_f32 v37, v37
  v_exp_f32 v39, v39
  v_exp_f32 v41, v41
  v_exp_f32 v43, v43
  v_pk_add_f32 v[36:37], v[36:37], 1.0 op_sel_hi:[1,0]
  v_pk_add_f32 v[38:39], v[38:39], 1.0 op_sel_hi:[1,0]
  v_pk_add_f32 v[40:41], v[40:41], 1.0 op_sel_hi:[1,0]
  v_pk_add_f32 v[42:43], v[42:43], 1.0 op_sel_hi:[1,0]
  v_rcp_f32 v36, v36
  v_rcp_f32 v38, v38
  v_rcp_f32 v40, v40
  v_rcp_f32 v42, v42
  v_rcp_f32 v37, v37
  v_rcp_f32 v39, v39
  v_rcp_f32 v41, v41
  v_rcp_f32 v43, v43
  v_pk_mul_f32 v[80:81], v[80:81], v[36:37]
  v_pk_mul_f32 v[82:83], v[82:83], v[38:39]
  v_pk_mul_f32 v[100:101], v[100:101], v[40:41]
  v_pk_mul_f32 v[102:103], v[102:103], v[42:43]
  v_cvt_pk_bf16_f32 v44, v80, v81
  v_cvt_pk_bf16_f32 v45, v82, v83
  v_cvt_pk_bf16_f32 v46, v100, v101
  v_cvt_pk_bf16_f32 v47, v102, v103
  buffer_store_dwordx4 v[44:47], v34, s[88:91], s57 offen sc1
Lg3skip_13:
  s_waitcnt vmcnt(0)
  v_mov_b32 v2, 163588
  v_mov_b32 v3, 1
  s_mov_b64 exec, 1
  ds_add_rtn_u32 v3, v2, v3
  s_waitcnt lgkmcnt(0)
  v_readfirstlane_b32 s3, v3
  s_mov_b64 exec, -1
  s_cmp_lg_u32 s3, 3
  s_cbranch_scc1 Lpub_14
  s_mov_b64 exec, 1
  v_mov_b32 v2, s4
  v_mov_b32 v3, 1
  buffer_atomic_add v3, v2, s[12:15], 0 offen sc1
  s_mov_b64 exec, -1
Lpub_14:
  s_branch L_c_p4b
LB_loader:
  s_cmp_lg_u32 s39, 127
  s_cbranch_scc1 LB_nowatch
  s_cmp_lg_u32 s41, 0
  s_cbranch_scc1 LB_nowatch
  s_mov_b32 s3, 262144
  v_mov_b32 v2, 0
  v_mov_b32 v3, 0
  s_mov_b32 vcc_lo, 0
  v_writelane_b32 v2, vcc_lo, 0
  s_mov_b32 vcc_lo, 16
  v_writelane_b32 v3, vcc_lo, 0
  s_mov_b32 vcc_lo, 4
  v_writelane_b32 v2, vcc_lo, 1
  s_mov_b32 vcc_lo, 16
  v_writelane_b32 v3, vcc_lo, 1
  s_mov_b32 vcc_lo, 64
  v_writelane_b32 v2, vcc_lo, 2
  s_mov_b32 vcc_lo, 16
  v_writelane_b32 v3, vcc_lo, 2
  s_mov_b32 vcc_lo, 68
  v_writelane_b32 v2, vcc_lo, 3
  s_mov_b32 vcc_lo, 16
  v_writelane_b32 v3, vcc_lo, 3
  s_mov_b32 vcc_lo, 128
  v_writelane_b32 v2, vcc_lo, 4
  s_mov_b32 vcc_lo, 16
  v_writelane_b32 v3, vcc_lo, 4
  s_mov_b32 vcc_lo, 132
  v_writelane_b32 v2, vcc_lo, 5
  s_mov_b32 vcc_lo, 16
  v_writelane_b32 v3, vcc_lo, 5
  s_mov_b32 vcc_lo, 192
  v_writelane_b32 v2, vcc_lo, 6
  s_mov_b32 vcc_lo, 16
  v_writelane_b32 v3, vcc_lo, 6
  s_mov_b32 vcc_lo, 196
  v_writelane_b32 v2, vcc_lo, 7
  s_mov_b32 vcc_lo, 16
  v_writelane_b32 v3, vcc_lo, 7
LpollW_15:
  s_mov_b64 exec, 255
  buffer_load_dword v4, v2, s[8:11], 0 offen sc1
  s_mov_b64 exec, 255
  s_waitcnt vmcnt(0)
  v_cmp_lt_u32 vcc, v4, v3
  s_nop 3
  s_cmp_eq_u64 vcc, 0
  s_cbranch_scc1 LpolldW_16
  s_sleep 8
  s_sub_u32 s3, s3, 1
  s_cmp_lg_u32 s3, 0
  s_cbranch_scc1 LpollW_15
LpolldW_16:
  s_mov_b64 exec, -1
  s_mov_b64 exec, 3
  v_lshlrev_b32 v2, 6, v1
  v_add_u32 v2, 160, v2
  v_mov_b32 v3, 1
  buffer_store_dword v3, v2, s[8:11], 0 offen sc1
  s_mov_b64 exec, -1
LB_nowatch:
  s_cmp_ge_u32 s39, 112
  s_cbranch_scc1 LB_spare_ld
  s_mov_b32 s72, s24
  s_mov_b32 s73, s25
  s_mov_b32 s74, 7077888
  s_mov_b32 s75, 0x20000
  s_cmp_ge_u32 s41, 2
  s_cbranch_scc1 LB_ldB
  s_mul_i32 s46, s42, 327680
  s_lshr_b32 s44, s41, 1
  s_lshl_b32 s44, s44, 16
  s_add_u32 s46, s46, s44
  s_and_b32 s44, s41, 1
  s_lshl_b32 s44, s44, 10
  s_add_u32 s46, s46, s44
  v_lshl_add_u32 v2, v1, 4, s46
  v_lshrrev_b32 v4, 4, v1
  v_and_b32 v3, 15, v1
  v_lshlrev_b32 v52, 1, v4
  v_xor_b32 v3, v3, v52
  v_lshlrev_b32 v3, 4, v3
  v_mul_u32_u24 v4, 3456, v4
  s_lshl_b32 s44, s43, 8
  v_add_u32 v4, s44, v4
  v_add_u32 v52, 0, v2
  v_add_u32 v53, 131072, v2
  v_add_u32 v54, 262144, v2
  s_add_i32 s44, s41, 2
  s_bfe_u32 s45, s44, 0x10001
  s_lshl_b32 s45, s45, 7
  v_xor_b32 v55, s45, v3
  s_mul_i32 s44, s44, 13824
  v_add3_u32 v55, v55, v4, s44
  s_add_i32 s44, s41, 6
  s_bfe_u32 s45, s44, 0x10001
  s_lshl_b32 s45, s45, 7
  v_xor_b32 v56, s45, v3
  s_mul_i32 s44, s44, 13824
  v_add3_u32 v56, v56, v4, s44
  s_add_i32 s44, s41, 10
  s_bfe_u32 s45, s44, 0x10001
  s_lshl_b32 s45, s45, 7
  v_xor_b32 v57, s45, v3
  s_mul_i32 s44, s44, 13824
  v_add3_u32 v57, v57, v4, s44
  s_add_i32 s44, s41, 14
  s_bfe_u32 s45, s44, 0x10001
  s_lshl_b32 s45, s45, 7
  v_xor_b32 v58, s45, v3
  s_mul_i32 s44, s44, 13824
  v_add3_u32 v58, v58, v4, s44
  s_lshl_b32 s51, s41, 10
  s_mov_b32 s52, s51
  s_add_u32 s53, s51, 159744
  s_mul_i32 s49, s38, 2048
  s_mul_i32 s50, s38, 221184
  v_mov_b32 v2, 163584
Lkw_17:
  s_sleep 1
  ds_read_b32 v3, v2
  s_waitcnt lgkmcnt(0)
  v_readfirstlane_b32 s3, v3
  s_nop 0
  s_cmp_lt_u32 s3, 4
  s_cbranch_scc1 Lkw_17
  s_mov_b32 s51, s52
  s_mov_b32 s47, 5
Lps_18:
  s_add_u32 m0, s51, 12288
  s_nop 0
  buffer_load_dwordx4 v55, s[72:75], s50 offen  lds
  s_add_u32 m0, s51, 16384
  s_nop 0
  buffer_load_dwordx4 v56, s[72:75], s50 offen  lds
  s_add_u32 m0, s51, 20480
  s_nop 0
  buffer_load_dwordx4 v57, s[72:75], s50 offen  lds
  s_add_u32 m0, s51, 24576
  s_nop 0
  buffer_load_dwordx4 v58, s[72:75], s50 offen  lds
  s_add_u32 s50, s50, 221184
  s_cmp_eq_u32 s50, 7077888
  s_cselect_b32 s50, 0, s50
  s_add_u32 s51, s51, 26624
  s_cmp_eq_u32 s51, s53
  s_cselect_b32 s51, s52, s51
  s_sub_u32 s47, s47, 1
  s_cmp_lg_u32 s47, 0
  s_cbranch_scc1 Lps_18
  v_mov_b32 v2, 163592
Lfw_19:
  ds_read_b32 v3, v2
  s_waitcnt lgkmcnt(0)
  v_readfirstlane_b32 s3, v3
  s_nop 0
  s_cmp_lg_u32 s3, 0
  s_cbranch_scc1 Lfd_20
  s_sleep 1
  s_branch Lfw_19
Lfd_20:
  s_mov_b32 s51, s52
  s_mov_b32 s47, 5
Lps_21:
  s_add_u32 m0, s51, 0
  s_nop 0
  buffer_load_dwordx4 v52, s[64:67], s49 offen sc1 lds
  s_add_u32 m0, s51, 4096
  s_nop 0
  buffer_load_dwordx4 v53, s[64:67], s49 offen sc1 lds
  s_add_u32 m0, s51, 8192
  s_nop 0
  buffer_load_dwordx4 v54, s[64:67], s49 offen sc1 lds
  s_add_u32 s49, s49, 2048
  s_cmp_eq_u32 s49, 65536
  s_cselect_b32 s49, 0, s49
  s_add_u32 s51, s51, 26624
  s_cmp_eq_u32 s51, s53
  s_cselect_b32 s51, s52, s51
  s_sub_u32 s47, s47, 1
  s_cmp_lg_u32 s47, 0
  s_cbranch_scc1 Lps_21
  s_mov_b32 m0, s51
  s_mov_b32 s47, 5
Lle_22:
  s_cmp_lg_u32 s47, 5
  s_cbranch_scc1 Lnx_24
  s_waitcnt vmcnt(12)
  s_branch Lgo_23
Lnx_24:
  s_cmp_lg_u32 s47, 4
  s_cbranch_scc1 Lnx_25
  s_waitcnt vmcnt(16)
  s_branch Lgo_23
Lnx_25:
  s_cmp_lg_u32 s47, 3
  s_cbranch_scc1 Lnx_26
  s_waitcnt vmcnt(20)
  s_branch Lgo_23
Lnx_26:
  s_cmp_lg_u32 s47, 2
  s_cbranch_scc1 Lnx_27
  s_waitcnt vmcnt(24)
  v_mov_b32 v2, 163604
Lfw_28:
  ds_read_b32 v3, v2
  s_waitcnt lgkmcnt(0)
  v_readfirstlane_b32 s3, v3
  s_nop 0
  s_cmp_lg_u32 s3, 0
  s_cbranch_scc1 Lfd_29
  s_sleep 1
  s_branch Lfw_28
Lfd_29:
  s_branch Lgo_23
Lnx_27:
  s_waitcnt vmcnt(28)
Lgo_23:
  s_barrier
  buffer_load_dwordx4 v52, s[64:67], s49 offen sc1 lds
  s_add_u32 m0, s51, 4096
  s_add_u32 s46, s50, 221184
  s_cmp_eq_u32 s46, 7077888
  s_cselect_b32 s46, 0, s46
  buffer_load_dwordx4 v53, s[64:67], s49 offen sc1 lds
  s_add_u32 m0, s51, 8192
  s_nop 0
  buffer_load_dwordx4 v54, s[64:67], s49 offen sc1 lds
  s_add_u32 m0, s51, 12288
  s_add_u32 s49, s49, 2048
  s_cmp_eq_u32 s49, 65536
  s_cselect_b32 s49, 0, s49
  buffer_load_dwordx4 v55, s[72:75], s50 offen  lds
  s_add_u32 m0, s51, 16384
  s_nop 0
  buffer_load_dwordx4 v56, s[72:75], s50 offen  lds
  s_add_u32 m0, s51, 20480
  s_nop 0
  buffer_load_dwordx4 v57, s[72:75], s50 offen  lds
  s_add_u32 m0, s51, 24576
  s_add_u32 s51, s51, 26624
  s_cmp_eq_u32 s51, s53
  s_cselect_b32 s51, s52, s51
  s_sub_u32 s47, s47, 1
  s_cmp_lg_u32 s47, 0
  buffer_load_dwordx4 v58, s[72:75], s50 offen  lds
  s_mov_b32 s50, s46
  s_mov_b32 m0, s51
  s_cbranch_scc1 Lle_22
  s_mov_b32 s47, 22
  s_waitcnt vmcnt(28)
  s_barrier
  buffer_load_dwordx4 v52, s[64:67], s49 offen sc1 lds
  s_add_u32 m0, s51, 4096
  s_add_u32 s46, s50, 221184
  s_cmp_eq_u32 s46, 7077888
  s_cselect_b32 s46, 0, s46
Lld_31:
  buffer_load_dwordx4 v53, s[64:67], s49 offen sc1 lds
  s_add_u32 m0, s51, 8192
  s_nop 0
  buffer_load_dwordx4 v54, s[64:67], s49 offen sc1 lds
  s_add_u32 m0, s51, 12288
  s_add_u32 s49, s49, 2048
  s_cmp_eq_u32 s49, 65536
  s_cselect_b32 s49, 0, s49
  buffer_load_dwordx4 v55, s[72:75], s50 offen  lds
  s_add_u32 m0, s51, 16384
  s_nop 0
  buffer_load_dwordx4 v56, s[72:75], s50 offen  lds
  s_add_u32 m0, s51, 20480
  s_nop 0
  buffer_load_dwordx4 v57, s[72:75], s50 offen  lds
  s_add_u32 m0, s51, 24576
  s_add_u32 s51, s51, 26624
  s_cmp_eq_u32 s51, s53
  s_cselect_b32 s51, s52, s51
  s_sub_u32 s47, s47, 1
  s_cmp_lg_u32 s47, 0
  buffer_load_dwordx4 v58, s[72:75], s50 offen  lds
  s_mov_b32 s50, s46
  s_mov_b32 m0, s51
  s_cbranch_scc0 Lldx_32
  s_waitcnt vmcnt(28)
  s_barrier
  buffer_load_dwordx4 v52, s[64:67], s49 offen sc1 lds
  s_add_u32 m0, s51, 4096
  s_add_u32 s46, s50, 221184
  s_cmp_eq_u32 s46, 7077888
  s_cselect_b32 s46, 0, s46
  s_branch Lld_31
Lldx_32:
  s_and_b32 s44, s2, 7
  s_lshr_b32 s45, s2, 3
  s_and_b32 s42, s44, 1
  s_lshl_b32 s42, s42, 2
  s_and_b32 s46, s45, 3
  s_add_u32 s42, s42, s46
  s_lshr_b32 s43, s44, 1
  s_lshl_b32 s43, s43, 3
  s_lshr_b32 s45, s45, 2
  s_add_u32 s43, s43, s45
  s_mul_i32 s44, s46, 0
  s_add_u32 s44, s44, s45
  s_cmp_ge_u32 s44, 10
  s_cselect_b32 s56, 10, 0
  s_sub_u32 s56, s44, s56
  s_mul_i32 s46, s46, 7
  s_mul_i32 s45, s45, 0
  s_add_u32 s45, s45, s46
  s_mul_i32 s44, s45, 2428
  s_lshr_b32 s44, s44, 16
  s_mul_i32 s44, s44, 27
  s_sub_u32 s38, s45, s44
  s_add_u32 s60, s36, 2629632
  s_addc_u32 s61, s37, 0
  s_mov_b32 s62, 2211840
  s_mov_b32 s63, 0x20000
  s_add_u32 s68, s36, 4845568
  s_addc_u32 s69, s37, 0
  s_mov_b32 s70, 2621440
  s_mov_b32 s71, 0x20000
  s_mov_b32 s64, s20
  s_mov_b32 s65, s21
  s_mov_b32 s66, 819200
  s_mov_b32 s67, 0x20000
  s_mov_b32 s72, s28
  s_mov_b32 s73, s29
  s_mov_b32 s74, 7077888
  s_mov_b32 s75, 0x20000
  s_lshr_b32 s4, s43, 1
  s_lshl_b32 s4, s4, 7
  s_lshl_b32 s5, s42, 7
  s_add_u32 s5, s5, 2048
  s_lshl_b32 s46, s43, 2
  s_mul_i32 s46, s46, 20480
  v_lshl_add_u32 v2, v1, 4, s46
  s_add_u32 s44, s41, 0
  s_lshl_b32 s44, s44, 6
  v_add_u32 v3, s44, v1
  v_mul_u32_u24 v4, 6554, v3
  v_lshrrev_b32 v4, 16, v4
  v_mul_u32_u24 v26, 10, v4
  v_sub_u32 v3, v3, v26
  v_mul_u32_u24 v4, 1280, v4
  v_lshl_add_u32 v26, v3, 4, v4
  s_mul_i32 s44, s42, 160
  v_add_u32 v26, s44, v26
  s_add_u32 s44, s41, 4
  s_lshl_b32 s44, s44, 6
  v_add_u32 v3, s44, v1
  v_mul_u32_u24 v4, 6554, v3
  v_lshrrev_b32 v4, 16, v4
  v_mul_u32_u24 v27, 10, v4
  v_sub_u32 v3, v3, v27
  v_mul_u32_u24 v4, 1280, v4
  v_lshl_add_u32 v27, v3, 4, v4
  s_mul_i32 s44, s42, 160
  v_add_u32 v27, s44, v27
  s_add_u32 s44, s41, 8
  s_lshl_b32 s44, s44, 6
  v_add_u32 v3, s44, v1
  v_mul_u32_u24 v4, 6554, v3
  v_lshrrev_b32 v4, 16, v4
  v_mul_u32_u24 v28, 10, v4
  v_sub_u32 v3, v3, v28
  v_mul_u32_u24 v4, 1280, v4
  v_lshl_add_u32 v28, v3, 4, v4
  s_mul_i32 s44, s42, 160
  v_add_u32 v28, s44, v28
  s_add_i32 s44, s41, 2
  s_lshr_b32 s45, s44, 1
  s_mul_i32 s45, s45, 20480
  s_and_b32 s44, s44, 1
  s_lshl_b32 s44, s44, 10
  s_add_u32 s44, s44, s45
  v_add_u32 v29, s44, v2
  s_add_i32 s44, s41, 6
  s_lshr_b32 s45, s44, 1
  s_mul_i32 s45, s45, 20480
  s_and_b32 s44, s44, 1
  s_lshl_b32 s44, s44, 10
  s_add_u32 s44, s44, s45
  v_add_u32 v30, s44, v2
  s_mul_i32 s46, s42, 276480
  s_lshr_b32 s44, s41, 1
  s_mul_i32 s44, s44, 55296
  s_add_u32 s46, s46, s44
  s_and_b32 s44, s41, 1
  s_lshl_b32 s44, s44, 10
  s_add_u32 s46, s46, s44
  v_lshl_add_u32 v2, v1, 4, s46
  v_lshrrev_b32 v4, 4, v1
  v_lshlrev_b32 v4, 1, v4
  v_and_b32 v3, 7, v1
  v_xor_b32 v3, v3, v4
  v_lshlrev_b32 v3, 4, v3
  v_lshrrev_b32 v4, 3, v1
  v_lshl_add_u32 v3, v4, 12, v3
  s_lshl_b32 s44, s43, 7
  v_add_u32 v3, s44, v3
  v_add_u32 v31, 0, v2
  v_add_u32 v32, 110592, v2
  v_add_u32 v33, 221184, v2
  s_add_i32 s44, s41, 2
  s_lshl_b32 s44, s44, 15
  v_add_u32 v34, s44, v3
  s_add_i32 s44, s41, 6
  s_lshl_b32 s44, s44, 15
  v_add_u32 v35, s44, v3
  s_lshl_b32 s51, s41, 10
  s_mov_b32 s52, s51
  s_add_u32 s53, s51, 110592
  s_mul_i32 s49, s56, 2048
  s_mul_i32 s50, s56, 81920
  s_mul_i32 s57, s38, 2048
  s_mul_i32 s58, s38, 262144
  s_cmp_lg_u32 s41, 0
  s_cbranch_scc1 Lto_33
  v_mov_b32 v36, s4
  buffer_load_dword v37, v36, s[12:15], 0 offen sc1
Lto_33:
  s_waitcnt vmcnt(28)
  s_barrier
  s_waitcnt vmcnt(21)
  s_barrier
  s_waitcnt vmcnt(14)
  s_barrier
  s_waitcnt vmcnt(7)
  s_barrier
  s_waitcnt vmcnt(0)
  s_barrier
  s_barrier
  s_mov_b32 s7, 1
  s_branch L_l_p4_v0
LB_ldB:
  s_mul_i32 s46, s42, 327680
  s_lshr_b32 s44, s41, 1
  s_lshl_b32 s44, s44, 16
  s_add_u32 s46, s46, s44
  s_and_b32 s44, s41, 1
  s_lshl_b32 s44, s44, 10
  s_add_u32 s46, s46, s44
  v_lshl_add_u32 v2, v1, 4, s46
  v_lshrrev_b32 v4, 4, v1
  v_and_b32 v3, 15, v1
  v_lshlrev_b32 v52, 1, v4
  v_xor_b32 v3, v3, v52
  v_lshlrev_b32 v3, 4, v3
  v_mul_u32_u24 v4, 3456, v4
  s_lshl_b32 s44, s43, 8
  v_add_u32 v4, s44, v4
  v_add_u32 v52, 0, v2
  v_add_u32 v53, 131072, v2
  s_add_i32 s44, s41, -2
  s_bfe_u32 s45, s44, 0x10001
  s_lshl_b32 s45, s45, 7
  v_xor_b32 v54, s45, v3
  s_mul_i32 s44, s44, 13824
  v_add3_u32 v54, v54, v4, s44
  s_add_i32 s44, s41, 2
  s_bfe_u32 s45, s44, 0x10001
  s_lshl_b32 s45, s45, 7
  v_xor_b32 v55, s45, v3
  s_mul_i32 s44, s44, 13824
  v_add3_u32 v55, v55, v4, s44
  s_add_i32 s44, s41, 6
  s_bfe_u32 s45, s44, 0x10001
  s_lshl_b32 s45, s45, 7
  v_xor_b32 v56, s45, v3
  s_mul_i32 s44, s44, 13824
  v_add3_u32 v56, v56, v4, s44
  s_add_i32 s44, s41, 10
  s_bfe_u32 s45, s44, 0x10001
  s_lshl_b32 s45, s45, 7
  v_xor_b32 v57, s45, v3
  s_mul_i32 s44, s44, 13824
  v_add3_u32 v57, v57, v4, s44
  s_lshl_b32 s51, s41, 10
  s_mov_b32 s52, s51
  s_add_u32 s53, s51, 159744
  s_mul_i32 s49, s38, 2048
  s_mul_i32 s50, s38, 221184
  v_mov_b32 v2, 163584
Lkw_34:
  s_sleep 1
  ds_read_b32 v3, v2
  s_waitcnt lgkmcnt(0)
  v_readfirstlane_b32 s3, v3
  s_nop 0
  s_cmp_lt_u32 s3, 4
  s_cbranch_scc1 Lkw_34
  s_mov_b32 s51, s52
  s_mov_b32 s47, 5
Lps_35:
  s_add_u32 m0, s51, 8192
  s_nop 0
  buffer_load_dwordx4 v54, s[72:75], s50 offen  lds
  s_add_u32 m0, s51, 12288
  s_nop 0
  buffer_load_dwordx4 v55, s[72:75], s50 offen  lds
  s_add_u32 m0, s51, 16384
  s_nop 0
  buffer_load_dwordx4 v56, s[72:75], s50 offen  lds
  s_add_u32 m0, s51, 20480
  s_nop 0
  buffer_load_dwordx4 v57, s[72:75], s50 offen  lds
  s_add_u32 s50, s50, 221184
  s_cmp_eq_u32 s50, 7077888
  s_cselect_b32 s50, 0, s50
  s_add_u32 s51, s51, 26624
  s_cmp_eq_u32 s51, s53
  s_cselect_b32 s51, s52, s51
  s_sub_u32 s47, s47, 1
  s_cmp_lg_u32 s47, 0
  s_cbranch_scc1 Lps_35
  v_mov_b32 v2, 163592
Lfw_36:
  ds_read_b32 v3, v2
  s_waitcnt lgkmcnt(0)
  v_readfirstlane_b32 s3, v3
  s_nop 0
  s_cmp_lg_u32 s3, 0
  s_cbranch_scc1 Lfd_37
  s_sleep 1
  s_branch Lfw_36
Lfd_37:
  s_mov_b32 s51, s52
  s_mov_b32 s47, 5
Lps_38:
  s_add_u32 m0, s51, 0
  s_nop 0
  buffer_load_dwordx4 v52, s[64:67], s49 offen sc1 lds
  s_add_u32 m0, s51, 4096
  s_nop 0
  buffer_load_dwordx4 v53, s[64:67], s49 offen sc1 lds
  s_add_u32 s49, s49, 2048
  s_cmp_eq_u32 s49, 65536
  s_cselect_b32 s49, 0, s49
  s_add_u32 s51, s51, 26624
  s_cmp_eq_u32 s51, s53
  s_cselect_b32 s51, s52, s51
  s_sub_u32 s47, s47, 1
  s_cmp_lg_u32 s47, 0
  s_cbranch_scc1 Lps_38
  s_mov_b32 m0, s51
  s_mov_b32 s47, 5
Lle_39:
  s_cmp_lg_u32 s47, 5
  s_cbranch_scc1 Lnx_41
  s_waitcnt vmcnt(8)
  s_branch Lgo_40
Lnx_41:
  s_cmp_lg_u32 s47, 4
  s_cbranch_scc1 Lnx_42
  s_waitcnt vmcnt(12)
  s_branch Lgo_40
Lnx_42:
  s_cmp_lg_u32 s47, 3
  s_cbranch_scc1 Lnx_43
  s_waitcnt vmcnt(16)
  s_branch Lgo_40
Lnx_43:
  s_cmp_lg_u32 s47, 2
  s_cbranch_scc1 Lnx_44
  s_waitcnt vmcnt(20)
  v_mov_b32 v2, 163604
Lfw_45:
  ds_read_b32 v3, v2
  s_waitcnt lgkmcnt(0)
  v_readfirstlane_b32 s3, v3
  s_nop 0
  s_cmp_lg_u32 s3, 0
  s_cbranch_scc1 Lfd_46
  s_sleep 1
  s_branch Lfw_45
Lfd_46:
  s_branch Lgo_40
Lnx_44:
  s_waitcnt vmcnt(24)
Lgo_40:
  s_barrier
  buffer_load_dwordx4 v52, s[64:67], s49 offen sc1 lds
  s_add_u32 m0, s51, 4096
  s_add_u32 s46, s50, 221184
  s_cmp_eq_u32 s46, 7077888
  s_cselect_b32 s46, 0, s46
  buffer_load_dwordx4 v53, s[64:67], s49 offen sc1 lds
  s_add_u32 m0, s51, 8192
  s_add_u32 s49, s49, 2048
  s_cmp_eq_u32 s49, 65536
  s_cselect_b32 s49, 0, s49
  buffer_load_dwordx4 v54, s[72:75], s50 offen  lds
  s_add_u32 m0, s51, 12288
  s_nop 0
  buffer_load_dwordx4 v55, s[72:75], s50 offen  lds
  s_add_u32 m0, s51, 16384
  s_nop 0
  buffer_load_dwordx4 v56, s[72:75], s50 offen  lds
  s_add_u32 m0, s51, 20480
  s_add_u32 s51, s51, 26624
  s_cmp_eq_u32 s51, s53
  s_cselect_b32 s51, s52, s51
  s_sub_u32 s47, s47, 1
  s_cmp_lg_u32 s47, 0
  buffer_load_dwordx4 v57, s[72:75], s50 offen  lds
  s_mov_b32 s50, s46
  s_mov_b32 m0, s51
  s_cbranch_scc1 Lle_39
  s_mov_b32 s47, 22
  s_waitcnt vmcnt(24)
  s_barrier
  buffer_load_dwordx4 v52, s[64:67], s49 offen sc1 lds
  s_add_u32 m0, s51, 4096
  s_add_u32 s46, s50, 221184
  s_cmp_eq_u32 s46, 7077888
  s_cselect_b32 s46, 0, s46
Lld_48:
  buffer_load_dwordx4 v53, s[64:67], s49 offen sc1 lds
  s_add_u32 m0, s51, 8192
  s_add_u32 s49, s49, 2048
  s_cmp_eq_u32 s49, 65536
  s_cselect_b32 s49, 0, s49
  buffer_load_dwordx4 v54, s[72:75], s50 offen  lds
  s_add_u32 m0, s51, 12288
  s_nop 0
  buffer_load_dwordx4 v55, s[72:75], s50 offen  lds
  s_add_u32 m0, s51, 16384
  s_nop 0
  buffer_load_dwordx4 v56, s[72:75], s50 offen  lds
  s_add_u32 m0, s51, 20480
  s_add_u32 s51, s51, 26624
  s_cmp_eq_u32 s51, s53
  s_cselect_b32 s51, s52, s51
  s_sub_u32 s47, s47, 1
  s_cmp_lg_u32 s47, 0
  buffer_load_dwordx4 v57, s[72:75], s50 offen  lds
  s_mov_b32 s50, s46
  s_mov_b32 m0, s51
  s_cbranch_scc0 Lldx_49
  s_waitcnt vmcnt(24)
  s_barrier
  buffer_load_dwordx4 v52, s[64:67], s49 offen sc1 lds
  s_add_u32 m0, s51, 4096
  s_add_u32 s46, s50, 221184
  s_cmp_eq_u32 s46, 7077888
  s_cselect_b32 s46, 0, s46
  s_branch Lld_48
Lldx_49:
  s_and_b32 s44, s2, 7
  s_lshr_b32 s45, s2, 3
  s_and_b32 s42, s44, 1
  s_lshl_b32 s42, s42, 2
  s_and_b32 s46, s45, 3
  s_add_u32 s42, s42, s46
  s_lshr_b32 s43, s44, 1
  s_lshl_b32 s43, s43, 3
  s_lshr_b32 s45, s45, 2
  s_add_u32 s43, s43, s45
  s_mul_i32 s44, s46, 0
  s_add_u32 s44, s44, s45
  s_cmp_ge_u32 s44, 10
  s_cselect_b32 s56, 10, 0
  s_sub_u32 s56, s44, s56
  s_mul_i32 s46, s46, 7
  s_mul_i32 s45, s45, 0
  s_add_u32 s45, s45, s46
  s_mul_i32 s44, s45, 2428
  s_lshr_b32 s44, s44, 16
  s_mul_i32 s44, s44, 27
  s_sub_u32 s38, s45, s44
  s_add_u32 s60, s36, 2629632
  s_addc_u32 s61, s37, 0
  s_mov_b32 s62, 2211840
  s_mov_b32 s63, 0x20000
  s_add_u32 s68, s36, 4845568
  s_addc_u32 s69, s37, 0
  s_mov_b32 s70, 2621440
  s_mov_b32 s71, 0x20000
  s_mov_b32 s64, s20
  s_mov_b32 s65, s21
  s_mov_b32 s66, 819200
  s_mov_b32 s67, 0x20000
  s_mov_b32 s72, s28
  s_mov_b32 s73, s29
  s_mov_b32 s74, 7077888
  s_mov_b32 s75, 0x20000
  s_lshr_b32 s4, s43, 1
  s_lshl_b32 s4, s4, 7
  s_lshl_b32 s5, s42, 7
  s_add_u32 s5, s5, 2048
  s_lshl_b32 s46, s43, 2
  s_mul_i32 s46, s46, 20480
  v_lshl_add_u32 v2, v1, 4, s46
  s_add_u32 s44, s41, 0
  s_lshl_b32 s44, s44, 6
  v_add_u32 v3, s44, v1
  v_mul_u32_u24 v4, 6554, v3
  v_lshrrev_b32 v4, 16, v4
  v_mul_u32_u24 v26, 10, v4
  v_sub_u32 v3, v3, v26
  v_mul_u32_u24 v4, 1280, v4
  v_lshl_add_u32 v26, v3, 4, v4
  s_mul_i32 s44, s42, 160
  v_add_u32 v26, s44, v26
  s_add_u32 s44, s41, 4
  s_lshl_b32 s44, s44, 6
  v_add_u32 v3, s44, v1
  v_mul_u32_u24 v4, 6554, v3
  v_lshrrev_b32 v4, 16, v4
  v_mul_u32_u24 v27, 10, v4
  v_sub_u32 v3, v3, v27
  v_mul_u32_u24 v4, 1280, v4
  v_lshl_add_u32 v27, v3, 4, v4
  s_mul_i32 s44, s42, 160
  v_add_u32 v27, s44, v27
  s_add_i32 s44, s41, -2
  s_lshr_b32 s45, s44, 1
  s_mul_i32 s45, s45, 20480
  s_and_b32 s44, s44, 1
  s_lshl_b32 s44, s44, 10
  s_add_u32 s44, s44, s45
  v_add_u32 v28, s44, v2
  s_add_i32 s44, s41, 2
  s_lshr_b32 s45, s44, 1
  s_mul_i32 s45, s45, 20480
  s_and_b32 s44, s44, 1
  s_lshl_b32 s44, s44, 10
  s_add_u32 s44, s44, s45
  v_add_u32 v29, s44, v2
  s_mul_i32 s46, s42, 276480
  s_lshr_b32 s44, s41, 1
  s_mul_i32 s44, s44, 55296
  s_add_u32 s46, s46, s44
  s_and_b32 s44, s41, 1
  s_lshl_b32 s44, s44, 10
  s_add_u32 s46, s46, s44
  v_lshl_add_u32 v2, v1, 4, s46
  v_lshrrev_b32 v4, 4, v1
  v_lshlrev_b32 v4, 1, v4
  v_and_b32 v3, 7, v1
  v_xor_b32 v3, v3, v4
  v_lshlrev_b32 v3, 4, v3
  v_lshrrev_b32 v4, 3, v1
  v_lshl_add_u32 v3, v4, 12, v3
  s_lshl_b32 s44, s43, 7
  v_add_u32 v3, s44, v3
  v_add_u32 v31, 0, v2
  v_add_u32 v32, 110592, v2
  s_add_i32 s44, s41, -2
  s_lshl_b32 s44, s44, 15
  v_add_u32 v33, s44, v3
  s_add_i32 s44, s41, 2
  s_lshl_b32 s44, s44, 15
  v_add_u32 v34, s44, v3
  s_lshl_b32 s51, s41, 10
  s_mov_b32 s52, s51
  s_add_u32 s53, s51, 110592
  s_mul_i32 s49, s56, 2048
  s_mul_i32 s50, s56, 81920
  s_mul_i32 s57, s38, 2048
  s_mul_i32 s58, s38, 262144
  s_waitcnt vmcnt(24)
  s_barrier
  s_waitcnt vmcnt(18)
  s_barrier
  s_waitcnt vmcnt(12)
  s_barrier
  s_waitcnt vmcnt(6)
  s_barrier
  s_waitcnt vmcnt(0)
  s_barrier
  s_barrier
  s_mov_b32 s7, 1
  s_branch L_l_p4_v1
LB_spare_ld:
  s_branch L_l_p4_nok
L_roleA:
  s_waitcnt lgkmcnt(0)
  s_mov_b32 s8, s34
  s_mov_b32 s9, s35
  s_mov_b32 s10, 256
  s_mov_b32 s11, 0x20000
  s_add_u32 s12, s36, 12730368
  s_addc_u32 s13, s37, 0
  s_mov_b32 s14, 3072
  s_mov_b32 s15, 0x20000
  s_and_b32 s42, s57, 1
  s_lshl_b32 s42, s42, 2
  s_and_b32 s44, s59, 3
  s_add_u32 s42, s42, s44
  s_lshr_b32 s43, s57, 1
  s_lshl_b32 s43, s43, 3
  s_lshr_b32 s45, s59, 2
  s_add_u32 s43, s43, s45
  s_mul_i32 s44, s44, 3
  s_add_u32 s44, s44, s45
  s_cmp_ge_u32 s44, 10
  s_cselect_b32 s45, 10, 0
  s_sub_u32 s38, s44, s45
  s_mov_b32 s60, s16
  s_mov_b32 s61, s17
  s_mov_b32 s62, 2621440
  s_mov_b32 s63, 0x20000
  s_mov_b32 s64, s18
  s_mov_b32 s65, s19
  s_mov_b32 s66, 2457600
  s_mov_b32 s67, 0x20000
  s_cmp_ge_u32 s40, 4
  s_cbranch_scc1 LA_loader
  s_add_u32 s68, s36, 12713984
  s_addc_u32 s69, s37, 0
  s_mov_b32 s70, 16384
  s_mov_b32 s71, 0x20000
  s_add_u32 s72, s36, 4845568
  s_addc_u32 s73, s37, 0
  s_mov_b32 s74, 2621440
  s_mov_b32 s75, 0x20000
  s_mov_b32 s58, 0
  v_and_b32 v2, 15, v1
  v_lshrrev_b32 v3, 4, v1
  v_lshrrev_b32 v4, 1, v2
  v_xor_b32 v6, v3, v4
  v_lshlrev_b32 v6, 4, v6
  v_lshl_add_u32 v6, v2, 7, v6
  v_xor_b32 v7, 64, v6
  v_lshrrev_b32 v4, 2, v2
  v_and_b32 v8, 1, v3
  v_lshl_add_u32 v4, v8, 2, v4
  v_lshrrev_b32 v8, 1, v3
  v_lshl_add_u32 v4, v8, 4, v4
  v_mul_u32_u24 v8, 480, v4
  v_and_b32 v2, 3, v2
  v_lshl_add_u32 v8, v2, 3, v8
  s_lshl_b32 s44, s40, 7
  s_add_u32 s44, s44, 18432
  v_add_u32 v8, s44, v8
  v_lshlrev_b32 v2, 2, v1
  v_mov_b32 v3, 0x3f803f80
  s_mov_b64 exec, 0xffffffff
  v_add_u32 v4, 0, v2
  ds_write_b32 v4, v3
  v_add_u32 v4, 49152, v2
  ds_write_b32 v4, v3
  v_add_u32 v4, 98304, v2
  ds_write_b32 v4, v3
  s_mov_b64 exec, -1
  s_waitcnt lgkmcnt(0)
Lones_50:
  v_and_b32 v2, 15, v1
  v_lshrrev_b32 v3, 4, v1
  v_and_b32 v4, 1, v2
  v_mul_u32_u24 v28, 4608, v4
  v_lshrrev_b32 v29, 2, v2
  v_lshrrev_b32 v2, 1, v2
  v_lshl_add_u32 v28, v2, 6, v28
  s_lshl_b32 s44, s40, 4
  s_add_u32 s44, s44, 0
  v_add_u32 v2, s44, v3
  v_mul_u32_u24 v4, 13, v2
  v_lshrrev_b32 v4, 8, v4
  v_mul_u32_u24 v32, 36864, v4
  v_mul_u32_u24 v4, 20, v4
  v_sub_u32 v2, v2, v4
  v_mul_u32_u24 v4, 52, v2
  v_lshrrev_b32 v4, 8, v4
  v_mul_u32_u24 v5, 9216, v4
  v_add3_u32 v32, v32, v5, v28
  v_mul_u32_u24 v4, 5, v4
  v_sub_u32 v2, v2, v4
  v_lshrrev_b32 v4, 1, v2
  v_xor_b32 v4, v4, v29
  v_lshl_add_u32 v32, v4, 4, v32
  v_and_b32 v2, 1, v2
  v_lshl_add_u32 v32, v2, 3, v32
  s_lshl_b32 s44, s40, 4
  s_add_u32 s44, s44, 4
  v_add_u32 v2, s44, v3
  v_mul_u32_u24 v4, 13, v2
  v_lshrrev_b32 v4, 8, v4
  v_mul_u32_u24 v33, 36864, v4
  v_mul_u32_u24 v4, 20, v4
  v_sub_u32 v2, v2, v4
  v_mul_u32_u24 v4, 52, v2
  v_lshrrev_b32 v4, 8, v4
  v_mul_u32_u24 v5, 9216, v4
  v_add3_u32 v33, v33, v5, v28
  v_mul_u32_u24 v4, 5, v4
  v_sub_u32 v2, v2, v4
  v_lshrrev_b32 v4, 1, v2
  v_xor_b32 v4, v4, v29
  v_lshl_add_u32 v33, v4, 4, v33
  v_and_b32 v2, 1, v2
  v_lshl_add_u32 v33, v2, 3, v33
  s_lshl_b32 s44, s40, 4
  s_add_u32 s44, s44, 8
  v_add_u32 v2, s44, v3
  v_mul_u32_u24 v4, 13, v2
  v_lshrrev_b32 v4, 8, v4
  v_mul_u32_u24 v34, 36864, v4
  v_mul_u32_u24 v4, 20, v4
  v_sub_u32 v2, v2, v4
  v_mul_u32_u24 v4, 52, v2
  v_lshrrev_b32 v4, 8, v4
  v_mul_u32_u24 v5, 9216, v4
  v_add3_u32 v34, v34, v5, v28
  v_mul_u32_u24 v4, 5, v4
  v_sub_u32 v2, v2, v4
  v_lshrrev_b32 v4, 1, v2
  v_xor_b32 v4, v4, v29
  v_lshl_add_u32 v34, v4, 4, v34
  v_and_b32 v2, 1, v2
  v_lshl_add_u32 v34, v2, 3, v34
  s_lshl_b32 s44, s40, 4
  s_add_u32 s44, s44, 12
  v_add_u32 v2, s44, v3
  v_mul_u32_u24 v4, 13, v2
  v_lshrrev_b32 v4, 8, v4
  v_mul_u32_u24 v35, 36864, v4
  v_mul_u32_u24 v4, 20, v4
  v_sub_u32 v2, v2, v4
  v_mul_u32_u24 v4, 52, v2
  v_lshrrev_b32 v4, 8, v4
  v_mul_u32_u24 v5, 9216, v4
  v_add3_u32 v35, v35, v5, v28
  v_mul_u32_u24 v4, 5, v4
  v_sub_u32 v2, v2, v4
  v_lshrrev_b32 v4, 1, v2
  v_xor_b32 v4, v4, v29
  v_lshl_add_u32 v35, v4, 4, v35
  v_and_b32 v2, 1, v2
  v_lshl_add_u32 v35, v2, 3, v35
  v_mov_b64 v[40:41], 0
  v_mov_b64 v[42:43], 0
  v_mov_b64 v[44:45], 0
  v_mov_b64 v[46:47], 0
  v_mov_b64 v[48:49], 0
  v_mov_b64 v[50:51], 0
  v_mov_b64 v[52:53], 0
  v_mov_b64 v[54:55], 0
  v_mov_b64 v[56:57], 0
  v_mov_b64 v[58:59], 0
  v_mov_b64 v[60:61], 0
  v_mov_b64 v[62:63], 0
  v_mov_b64 v[64:65], 0
  v_mov_b64 v[66:67], 0
  v_mov_b64 v[68:69], 0
  v_mov_b64 v[70:71], 0
  v_mov_b64 v[72:73], 0
  v_mov_b64 v[74:75], 0
  v_mov_b64 v[76:77], 0
  v_mov_b64 v[78:79], 0
  v_mov_b64 v[80:81], 0
  v_mov_b64 v[82:83], 0
  v_mov_b64 v[84:85], 0
  v_mov_b64 v[86:87], 0
  v_mov_b64 v[88:89], 0
  v_mov_b64 v[90:91], 0
  v_mov_b64 v[92:93], 0
  v_mov_b64 v[94:95], 0
  v_mov_b64 v[96:97], 0
  v_mov_b64 v[98:99], 0
  v_mov_b64 v[100:101], 0
  v_mov_b64 v[102:103], 0
  v_mov_b64 v[104:105], 0
  v_mov_b64 v[106:107], 0
  v_mov_b64 v[108:109], 0
  v_mov_b64 v[110:111], 0
  v_mov_b64 v[112:113], 0
  v_mov_b64 v[114:115], 0
  v_mov_b64 v[116:117], 0
  v_mov_b64 v[118:119], 0
  v_mov_b64 v[120:121], 0
  v_mov_b64 v[122:123], 0
  v_mov_b64 v[124:125], 0
  v_mov_b64 v[126:127], 0
  v_mov_b64 v[128:129], 0
  v_mov_b64 v[130:131], 0
  v_mov_b64 v[132:133], 0
  v_mov_b64 v[134:135], 0
  v_mov_b64 v[136:137], 0
  v_mov_b64 v[138:139], 0
  v_mov_b64 v[140:141], 0
  v_mov_b64 v[142:143], 0
  v_mov_b64 v[144:145], 0
  v_mov_b64 v[146:147], 0
  v_mov_b64 v[148:149], 0
  v_mov_b64 v[150:151], 0
  v_mov_b64 v[152:153], 0
  v_mov_b64 v[154:155], 0
  v_mov_b64 v[156:157], 0
  v_mov_b64 v[158:159], 0
  v_mov_b64 v[160:161], 0
  v_mov_b64 v[162:163], 0
  v_mov_b64 v[164:165], 0
  v_mov_b64 v[166:167], 0
  v_mov_b64 v[168:169], 0
  v_mov_b64 v[170:171], 0
  v_mov_b64 v[172:173], 0
  v_mov_b64 v[174:175], 0
  v_mov_b64 v[176:177], 0
  v_mov_b64 v[178:179], 0
  v_mov_b64 v[180:181], 0
  v_mov_b64 v[182:183], 0
  s_mov_b32 s48, 0
  s_mov_b32 s47, 10
  s_barrier
  ds_read_b128 a[32:35], v6 offset:0
  ds_read_b64_tr_b16 a[0:1], v8 offset:0
  ds_read_b64_tr_b16 a[2:3], v8 offset:3840
  ds_read_b64_tr_b16 a[4:5], v8 offset:32
  ds_read_b64_tr_b16 a[6:7], v8 offset:3872
  ds_read_b64_tr_b16 a[8:9], v8 offset:64
  ds_read_b64_tr_b16 a[10:11], v8 offset:3904
  ds_read_b64_tr_b16 a[12:13], v8 offset:96
  ds_read_b64_tr_b16 a[14:15], v8 offset:3936
  ds_read_b128 a[36:39], v6 offset:2048
  ds_read_b128 a[40:43], v6 offset:4096
  ds_read_b128 a[44:47], v6 offset:6144
  ds_read_b128 a[48:51], v6 offset:8192
  s_waitcnt lgkmcnt(0)
Lc_51:
  s_cmp_lg_u32 s47, 4
  s_cbranch_scc1 Lhk_52
  v_mov_b32 v36, 160
  buffer_load_dword v37, v36, s[8:11], 0 offen sc1
Lhk_52:
  s_cmp_lg_u32 s47, 2
  s_cbranch_scc1 Lhk_53
  s_waitcnt vmcnt(0)
  v_cmp_gt_u32 vcc, 1, v37
  s_nop 3
  s_cmp_eq_u64 vcc, 0
  s_cbranch_scc0 Lhk_53
  s_mov_b32 s58, 1
  s_lshl_b32 s44, s43, 7
  s_add_i32 s44, s44, -16
  v_and_b32 v2, 15, v1
  v_add_u32 v2, s44, v2
  v_lshlrev_b32 v2, 3, v2
  buffer_load_dwordx2 v[10:11], v2, s[68:71], 0 offen sc1
  v_add_u32 v2, 128, v2
  buffer_load_dwordx2 v[12:13], v2, s[68:71], 0 offen sc1
  v_add_u32 v2, 128, v2
  buffer_load_dwordx2 v[14:15], v2, s[68:71], 0 offen sc1
  v_add_u32 v2, 128, v2
  buffer_load_dwordx2 v[16:17], v2, s[68:71], 0 offen sc1
  v_add_u32 v2, 128, v2
  buffer_load_dwordx2 v[18:19], v2, s[68:71], 0 offen sc1
  v_add_u32 v2, 128, v2
  buffer_load_dwordx2 v[20:21], v2, s[68:71], 0 offen sc1
  v_add_u32 v2, 128, v2
  buffer_load_dwordx2 v[22:23], v2, s[68:71], 0 offen sc1
  v_add_u32 v2, 128, v2
  buffer_load_dwordx2 v[24:25], v2, s[68:71], 0 offen sc1
  v_add_u32 v2, 128, v2
  buffer_load_dwordx2 v[26:27], v2, s[68:71], 0 offen sc1
Lhk_53:
  v_mfma_f32_16x16x32_bf16 v[40:43], a[0:3], a[32:35], v[40:43]
  ds_read_b128 a[52:55], v6 offset:10240
  ds_read_b128 a[56:59], v6 offset:12288
  v_mfma_f32_16x16x32_bf16 v[76:79], a[4:7], a[32:35], v[76:79]
  ds_read_b128 a[60:63], v6 offset:14336
  ds_read_b128 a[64:67], v6 offset:16384
  v_mfma_f32_16x16x32_bf16 v[112:115], a[8:11], a[32:35], v[112:115]
  v_mfma_f32_16x16x32_bf16 v[148:151], a[12:15], a[32:35], v[148:151]
  v_mfma_f32_16x16x32_bf16 v[44:47], a[0:3], a[36:39], v[44:47]
  v_mfma_f32_16x16x32_bf16 v[80:83], a[4:7], a[36:39], v[80:83]
  v_mfma_f32_16x16x32_bf16 v[116:119], a[8:11], a[36:39], v[116:119]
  v_mfma_f32_16x16x32_bf16 v[152:155], a[12:15], a[36:39], v[152:155]
  v_mfma_f32_16x16x32_bf16 v[48:51], a[0:3], a[40:43], v[48:51]
  v_mfma_f32_16x16x32_bf16 v[84:87], a[4:7], a[40:43], v[84:87]
  v_mfma_f32_16x16x32_bf16 v[120:123], a[8:11], a[40:43], v[120:123]
  v_mfma_f32_16x16x32_bf16 v[156:159], a[12:15], a[40:43], v[156:159]
  v_mfma_f32_16x16x32_bf16 v[52:55], a[0:3], a[44:47], v[52:55]
  v_mfma_f32_16x16x32_bf16 v[88:91], a[4:7], a[44:47], v[88:91]
  v_mfma_f32_16x16x32_bf16 v[124:127], a[8:11], a[44:47], v[124:127]
  v_mfma_f32_16x16x32_bf16 v[160:163], a[12:15], a[44:47], v[160:163]
  v_mfma_f32_16x16x32_bf16 v[56:59], a[0:3], a[48:51], v[56:59]
  v_mfma_f32_16x16x32_bf16 v[92:95], a[4:7], a[48:51], v[92:95]
  v_mfma_f32_16x16x32_bf16 v[128:131], a[8:11], a[48:51], v[128:131]
  v_mfma_f32_16x16x32_bf16 v[164:167], a[12:15], a[48:51], v[164:167]
  s_waitcnt lgkmcnt(0)
  v_mfma_f32_16x16x32_bf16 v[60:63], a[0:3], a[52:55], v[60:63]
  ds_read_b128 a[32:35], v7 offset:0
  ds_read_b64_tr_b16 a[16:17], v8 offset:15360
  v_mfma_f32_16x16x32_bf16 v[96:99], a[4:7], a[52:55], v[96:99]
  ds_read_b64_tr_b16 a[18:19], v8 offset:19200
  ds_read_b64_tr_b16 a[20:21], v8 offset:15392
  v_mfma_f32_16x16x32_bf16 v[132:135], a[8:11], a[52:55], v[132:135]
  ds_read_b64_tr_b16 a[22:23], v8 offset:19232
  ds_read_b64_tr_b16 a[24:25], v8 offset:15424
  v_mfma_f32_16x16x32_bf16 v[168:171], a[12:15], a[52:55], v[168:171]
  ds_read_b64_tr_b16 a[26:27], v8 offset:19264
  ds_read_b64_tr_b16 a[28:29], v8 offset:15456
  v_mfma_f32_16x16x32_bf16 v[64:67], a[0:3], a[56:59], v[64:67]
  ds_read_b64_tr_b16 a[30:31], v8 offset:19296
  ds_read_b128 a[36:39], v7 offset:2048
  v_mfma_f32_16x16x32_bf16 v[100:103], a[4:7], a[56:59], v[100:103]
  ds_read_b128 a[40:43], v7 offset:4096
  ds_read_b128 a[44:47], v7 offset:6144
  v_mfma_f32_16x16x32_bf16 v[136:139], a[8:11], a[56:59], v[136:139]
  ds_read_b128 a[48:51], v7 offset:8192
  v_mfma_f32_16x16x32_bf16 v[172:175], a[12:15], a[56:59], v[172:175]
  v_mfma_f32_16x16x32_bf16 v[68:71], a[0:3], a[60:63], v[68:71]
  v_mfma_f32_16x16x32_bf16 v[104:107], a[4:7], a[60:63], v[104:107]
  v_mfma_f32_16x16x32_bf16 v[140:143], a[8:11], a[60:63], v[140:143]
  v_mfma_f32_16x16x32_bf16 v[176:179], a[12:15], a[60:63], v[176:179]
  v_mfma_f32_16x16x32_bf16 v[72:75], a[0:3], a[64:67], v[72:75]
  v_mfma_f32_16x16x32_bf16 v[108:111], a[4:7], a[64:67], v[108:111]
  v_mfma_f32_16x16x32_bf16 v[144:147], a[8:11], a[64:67], v[144:147]
  v_mfma_f32_16x16x32_bf16 v[180:183], a[12:15], a[64:67], v[180:183]
  s_waitcnt lgkmcnt(0)
  v_mfma_f32_16x16x32_bf16 v[40:43], a[16:19], a[32:35], v[40:43]
  ds_read_b128 a[52:55], v7 offset:10240
  ds_read_b128 a[56:59], v7 offset:12288
  v_mfma_f32_16x16x32_bf16 v[76:79], a[20:23], a[32:35], v[76:79]
  ds_read_b128 a[60:63], v7 offset:14336
  ds_read_b128 a[64:67], v7 offset:16384
  v_mfma_f32_16x16x32_bf16 v[112:115], a[24:27], a[32:35], v[112:115]
  s_mov_b32 s54, 49152
  s_add_u32 s48, s48, 1
  s_cmp_eq_u32 s48, 3
  s_cselect_b32 s54, 4294868992, s54
  s_cselect_b32 s48, 0, s48
  v_add_u32 v6, s54, v6
  v_add_u32 v7, s54, v7
  v_mfma_f32_16x16x32_bf16 v[148:151], a[28:31], a[32:35], v[148:151]
  v_add_u32 v8, s54, v8
  v_mfma_f32_16x16x32_bf16 v[44:47], a[16:19], a[36:39], v[44:47]
  v_mfma_f32_16x16x32_bf16 v[80:83], a[20:23], a[36:39], v[80:83]
  v_mfma_f32_16x16x32_bf16 v[116:119], a[24:27], a[36:39], v[116:119]
  v_mfma_f32_16x16x32_bf16 v[152:155], a[28:31], a[36:39], v[152:155]
  v_mfma_f32_16x16x32_bf16 v[48:51], a[16:19], a[40:43], v[48:51]
  v_mfma_f32_16x16x32_bf16 v[84:87], a[20:23], a[40:43], v[84:87]
  v_mfma_f32_16x16x32_bf16 v[120:123], a[24:27], a[40:43], v[120:123]
  v_mfma_f32_16x16x32_bf16 v[156:159], a[28:31], a[40:43], v[156:159]
  v_mfma_f32_16x16x32_bf16 v[52:55], a[16:19], a[44:47], v[52:55]
  v_mfma_f32_16x16x32_bf16 v[88:91], a[20:23], a[44:47], v[88:91]
  v_mfma_f32_16x16x32_bf16 v[124:127], a[24:27], a[44:47], v[124:127]
  v_mfma_f32_16x16x32_bf16 v[160:163], a[28:31], a[44:47], v[160:163]
  v_mfma_f32_16x16x32_bf16 v[56:59], a[16:19], a[48:51], v[56:59]
  v_mfma_f32_16x16x32_bf16 v[92:95], a[20:23], a[48:51], v[92:95]
  v_mfma_f32_16x16x32_bf16 v[128:131], a[24:27], a[48:51], v[128:131]
  v_mfma_f32_16x16x32_bf16 v[164:167], a[28:31], a[48:51], v[164:167]
  s_waitcnt lgkmcnt(0)
  s_barrier
  v_mfma_f32_16x16x32_bf16 v[60:63], a[16:19], a[52:55], v[60:63]
  ds_read_b128 a[32:35], v6 offset:0
  ds_read_b64_tr_b16 a[0:1], v8 offset:0
  v_mfma_f32_16x16x32_bf16 v[96:99], a[20:23], a[52:55], v[96:99]
  ds_read_b64_tr_b16 a[2:3], v8 offset:3840
  ds_read_b64_tr_b16 a[4:5], v8 offset:32
  v_mfma_f32_16x16x32_bf16 v[132:135], a[24:27], a[52:55], v[132:135]
  ds_read_b64_tr_b16 a[6:7], v8 offset:3872
  ds_read_b64_tr_b16 a[8:9], v8 offset:64
  v_mfma_f32_16x16x32_bf16 v[168:171], a[28:31], a[52:55], v[168:171]
  ds_read_b64_tr_b16 a[10:11], v8 offset:3904
  ds_read_b64_tr_b16 a[12:13], v8 offset:96
  v_mfma_f32_16x16x32_bf16 v[64:67], a[16:19], a[56:59], v[64:67]
  ds_read_b64_tr_b16 a[14:15], v8 offset:3936
  ds_read_b128 a[36:39], v6 offset:2048
  v_mfma_f32_16x16x32_bf16 v[100:103], a[20:23], a[56:59], v[100:103]
  ds_read_b128 a[40:43], v6 offset:4096
  ds_read_b128 a[44:47], v6 offset:6144
  v_mfma_f32_16x16x32_bf16 v[136:139], a[24:27], a[56:59], v[136:139]
  ds_read_b128 a[48:51], v6 offset:8192
  v_mfma_f32_16x16x32_bf16 v[172:175], a[28:31], a[56:59], v[172:175]
  v_mfma_f32_16x16x32_bf16 v[68:71], a[16:19], a[60:63], v[68:71]
  v_mfma_f32_16x16x32_bf16 v[104:107], a[20:23], a[60:63], v[104:107]
  v_mfma_f32_16x16x32_bf16 v[140:143], a[24:27], a[60:63], v[140:143]
  v_mfma_f32_16x16x32_bf16 v[176:179], a[28:31], a[60:63], v[176:179]
  v_mfma_f32_16x16x32_bf16 v[72:75], a[16:19], a[64:67], v[72:75]
  v_mfma_f32_16x16x32_bf16 v[108:111], a[20:23], a[64:67], v[108:111]
  v_mfma_f32_16x16x32_bf16 v[144:147], a[24:27], a[64:67], v[144:147]
  v_mfma_f32_16x16x32_bf16 v[180:183], a[28:31], a[64:67], v[180:183]
  s_sub_u32 s47, s47, 1
  s_cmp_lg_u32 s47, 0
  s_waitcnt lgkmcnt(0)
  s_cbranch_scc1 Lc_51
  s_cmp_eq_u32 s58, 1
  s_cbranch_scc1 LA_havestats
  s_mov_b32 s3, 262144
  v_mov_b32 v28, 0
  v_mov_b32 v29, 0
  s_mov_b32 vcc_lo, 160
  v_writelane_b32 v28, vcc_lo, 0
  s_mov_b32 vcc_lo, 1
  v_writelane_b32 v29, vcc_lo, 0
LpollS1a_54:
  s_mov_b64 exec, 1
  buffer_load_dword v30, v28, s[8:11], 0 offen sc1
  s_mov_b64 exec, 1
  s_waitcnt vmcnt(0)
  v_cmp_lt_u32 vcc, v30, v29
  s_nop 3
  s_cmp_eq_u64 vcc, 0
  s_cbranch_scc1 LpolldS1a_55
  s_sleep 4
  s_sub_u32 s3, s3, 1
  s_cmp_lg_u32 s3, 0
  s_cbranch_scc1 LpollS1a_54
LpolldS1a_55:
  s_mov_b64 exec, -1
  s_lshl_b32 s44, s43, 7
  s_add_i32 s44, s44, -16
  v_and_b32 v2, 15, v1
  v_add_u32 v2, s44, v2
  v_lshlrev_b32 v2, 3, v2
  buffer_load_dwordx2 v[10:11], v2, s[68:71], 0 offen sc1
  v_add_u32 v2, 128, v2
  buffer_load_dwordx2 v[12:13], v2, s[68:71], 0 offen sc1
  v_add_u32 v2, 128, v2
  buffer_load_dwordx2 v[14:15], v2, s[68:71], 0 offen sc1
  v_add_u32 v2, 128, v2
  buffer_load_dwordx2 v[16:17], v2, s[68:71], 0 offen sc1
  v_add_u32 v2, 128, v2
  buffer_load_dwordx2 v[18:19], v2, s[68:71], 0 offen sc1
  v_add_u32 v2, 128, v2
  buffer_load_dwordx2 v[20:21], v2, s[68:71], 0 offen sc1
  v_add_u32 v2, 128, v2
  buffer_load_dwordx2 v[22:23], v2, s[68:71], 0 offen sc1
  v_add_u32 v2, 128, v2
  buffer_load_dwordx2 v[24:25], v2, s[68:71], 0 offen sc1
  v_add_u32 v2, 128, v2
  buffer_load_dwordx2 v[26:27], v2, s[68:71], 0 offen sc1
LA_havestats:
  s_waitcnt vmcnt(0) lgkmcnt(0)
  v_mov_b32_dpp v28, v40 row_newbcast:0 row_mask:0xf bank_mask:0xf
  v_mov_b32_dpp v29, v41 row_newbcast:0 row_mask:0xf bank_mask:0xf
  v_mov_b32_dpp v30, v42 row_newbcast:0 row_mask:0xf bank_mask:0xf
  v_mov_b32_dpp v31, v43 row_newbcast:0 row_mask:0xf bank_mask:0xf
  v_pk_fma_f32 v[40:41], v[28:29], v[10:11], v[40:41] op_sel_hi:[1,0,1] neg_lo:[0,1,0] neg_hi:[0,1,0]
  v_pk_fma_f32 v[42:43], v[30:31], v[10:11], v[42:43] op_sel_hi:[1,0,1] neg_lo:[0,1,0] neg_hi:[0,1,0]
  v_pk_mul_f32 v[40:41], v[40:41], v[10:11] op_sel:[0,1] op_sel_hi:[1,1]
  v_pk_mul_f32 v[42:43], v[42:43], v[10:11] op_sel:[0,1] op_sel_hi:[1,1]
  v_cvt_pk_bf16_f32 v36, v40, v41
  v_cvt_pk_bf16_f32 v37, v42, v43
  ds_write_b64 v32, v[36:37] offset:0
  v_pk_fma_f32 v[44:45], v[28:29], v[12:13], v[44:45] op_sel_hi:[1,0,1] neg_lo:[0,1,0] neg_hi:[0,1,0]
  v_pk_fma_f32 v[46:47], v[30:31], v[12:13], v[46:47] op_sel_hi:[1,0,1] neg_lo:[0,1,0] neg_hi:[0,1,0]
  v_pk_mul_f32 v[44:45], v[44:45], v[12:13] op_sel:[0,1] op_sel_hi:[1,1]
  v_pk_mul_f32 v[46:47], v[46:47], v[12:13] op_sel:[0,1] op_sel_hi:[1,1]
  v_cvt_pk_bf16_f32 v38, v44, v45
  v_cvt_pk_bf16_f32 v39, v46, v47
  ds_write_b64 v32, v[38:39] offset:512
  v_pk_fma_f32 v[48:49], v[28:29], v[14:15], v[48:49] op_sel_hi:[1,0,1] neg_lo:[0,1,0] neg_hi:[0,1,0]
  v_pk_fma_f32 v[50:51], v[30:31], v[14:15], v[50:51] op_sel_hi:[1,0,1] neg_lo:[0,1,0] neg_hi:[0,1,0]
  v_pk_mul_f32 v[48:49], v[48:49], v[14:15] op_sel:[0,1] op_sel_hi:[1,1]
  v_pk_mul_f32 v[50:51], v[50:51], v[14:15] op_sel:[0,1] op_sel_hi:[1,1]
  v_cvt_pk_bf16_f32 v36, v48, v49
  v_cvt_pk_bf16_f32 v37, v50, v51
  ds_write_b64 v32, v[36:37] offset:1024
  v_pk_fma_f32 v[52:53], v[28:29], v[16:17], v[52:53] op_sel_hi:[1,0,1] neg_lo:[0,1,0] neg_hi:[0,1,0]
  v_pk_fma_f32 v[54:55], v[30:31], v[16:17], v[54:55] op_sel_hi:[1,0,1] neg_lo:[0,1,0] neg_hi:[0,1,0]
  v_pk_mul_f32 v[52:53], v[52:53], v[16:17] op_sel:[0,1] op_sel_hi:[1,1]
  v_pk_mul_f32 v[54:55], v[54:55], v[16:17] op_sel:[0,1] op_sel_hi:[1,1]
  v_cvt_pk_bf16_f32 v38, v52, v53
  v_cvt_pk_bf16_f32 v39, v54, v55
  ds_write_b64 v32, v[38:39] offset:1536
  v_pk_fma_f32 v[56:57], v[28:29], v[18:19], v[56:57] op_sel_hi:[1,0,1] neg_lo:[0,1,0] neg_hi:[0,1,0]
  v_pk_fma_f32 v[58:59], v[30:31], v[18:19], v[58:59] op_sel_hi:[1,0,1] neg_lo:[0,1,0] neg_hi:[0,1,0]
  v_pk_mul_f32 v[56:57], v[56:57], v[18:19] op_sel:[0,1] op_sel_hi:[1,1]
  v_pk_mul_f32 v[58:59], v[58:59], v[18:19] op_sel:[0,1] op_sel_hi:[1,1]
  v_cvt_pk_bf16_f32 v36, v56, v57
  v_cvt_pk_bf16_f32 v37, v58, v59
  ds_write_b64 v32, v[36:37] offset:2048
  v_pk_fma_f32 v[60:61], v[28:29], v[20:21], v[60:61] op_sel_hi:[1,0,1] neg_lo:[0,1,0] neg_hi:[0,1,0]
  v_pk_fma_f32 v[62:63], v[30:31], v[20:21], v[62:63] op_sel_hi:[1,0,1] neg_lo:[0,1,0] neg_hi:[0,1,0]
  v_pk_mul_f32 v[60:61], v[60:61], v[20:21] op_sel:[0,1] op_sel_hi:[1,1]
  v_pk_mul_f32 v[62:63], v[62:63], v[20:21] op_sel:[0,1] op_sel_hi:[1,1]
  v_cvt_pk_bf16_f32 v38, v60, v61
  v_cvt_pk_bf16_f32 v39, v62, v63
  ds_write_b64 v32, v[38:39] offset:2560
  v_pk_fma_f32 v[64:65], v[28:29], v[22:23], v[64:65] op_sel_hi:[1,0,1] neg_lo:[0,1,0] neg_hi:[0,1,0]
  v_pk_fma_f32 v[66:67], v[30:31], v[22:23], v[66:67] op_sel_hi:[1,0,1] neg_lo:[0,1,0] neg_hi:[0,1,0]
  v_pk_mul_f32 v[64:65], v[64:65], v[22:23] op_sel:[0,1] op_sel_hi:[1,1]
  v_pk_mul_f32 v[66:67], v[66:67], v[22:23] op_sel:[0,1] op_sel_hi:[1,1]
  v_cvt_pk_bf16_f32 v36, v64, v65
  v_cvt_pk_bf16_f32 v37, v66, v67
  ds_write_b64 v32, v[36:37] offset:3072
  v_pk_fma_f32 v[68:69], v[28:29], v[24:25], v[68:69] op_sel_hi:[1,0,1] neg_lo:[0,1,0] neg_hi:[0,1,0]
  v_pk_fma_f32 v[70:71], v[30:31], v[24:25], v[70:71] op_sel_hi:[1,0,1] neg_lo:[0,1,0] neg_hi:[0,1,0]
  v_pk_mul_f32 v[68:69], v[68:69], v[24:25] op_sel:[0,1] op_sel_hi:[1,1]
  v_pk_mul_f32 v[70:71], v[70:71], v[24:25] op_sel:[0,1] op_sel_hi:[1,1]
  v_cvt_pk_bf16_f32 v38, v68, v69
  v_cvt_pk_bf16_f32 v39, v70, v71
  ds_write_b64 v32, v[38:39] offset:3584
  v_pk_fma_f32 v[72:73], v[28:29], v[26:27], v[72:73] op_sel_hi:[1,0,1] neg_lo:[0,1,0] neg_hi:[0,1,0]
  v_pk_fma_f32 v[74:75], v[30:31], v[26:27], v[74:75] op_sel_hi:[1,0,1] neg_lo:[0,1,0] neg_hi:[0,1,0]
  v_pk_mul_f32 v[72:73], v[72:73], v[26:27] op_sel:[0,1] op_sel_hi:[1,1]
  v_pk_mul_f32 v[74:75], v[74:75], v[26:27] op_sel:[0,1] op_sel_hi:[1,1]
  v_cvt_pk_bf16_f32 v36, v72, v73
  v_cvt_pk_bf16_f32 v37, v74, v75
  ds_write_b64 v32, v[36:37] offset:4096
  v_mov_b32_dpp v28, v76 row_newbcast:0 row_mask:0xf bank_mask:0xf
  v_mov_b32_dpp v29, v77 row_newbcast:0 row_mask:0xf bank_mask:0xf
  v_mov_b32_dpp v30, v78 row_newbcast:0 row_mask:0xf bank_mask:0xf
  v_mov_b32_dpp v31, v79 row_newbcast:0 row_mask:0xf bank_mask:0xf
  v_pk_fma_f32 v[76:77], v[28:29], v[10:11], v[76:77] op_sel_hi:[1,0,1] neg_lo:[0,1,0] neg_hi:[0,1,0]
  v_pk_fma_f32 v[78:79], v[30:31], v[10:11], v[78:79] op_sel_hi:[1,0,1] neg_lo:[0,1,0] neg_hi:[0,1,0]
  v_pk_mul_f32 v[76:77], v[76:77], v[10:11] op_sel:[0,1] op_sel_hi:[1,1]
  v_pk_mul_f32 v[78:79], v[78:79], v[10:11] op_sel:[0,1] op_sel_hi:[1,1]
  v_cvt_pk_bf16_f32 v36, v76, v77
  v_cvt_pk_bf16_f32 v37, v78, v79
  ds_write_b64 v33, v[36:37] offset:0
  v_pk_fma_f32 v[80:81], v[28:29], v[12:13], v[80:81] op_sel_hi:[1,0,1] neg_lo:[0,1,0] neg_hi:[0,1,0]
  v_pk_fma_f32 v[82:83], v[30:31], v[12:13], v[82:83] op_sel_hi:[1,0,1] neg_lo:[0,1,0] neg_hi:[0,1,0]
  v_pk_mul_f32 v[80:81], v[80:81], v[12:13] op_sel:[0,1] op_sel_hi:[1,1]
  v_pk_mul_f32 v[82:83], v[82:83], v[12:13] op_sel:[0,1] op_sel_hi:[1,1]
  v_cvt_pk_bf16_f32 v38, v80, v81
  v_cvt_pk_bf16_f32 v39, v82, v83
  ds_write_b64 v33, v[38:39] offset:512
  v_pk_fma_f32 v[84:85], v[28:29], v[14:15], v[84:85] op_sel_hi:[1,0,1] neg_lo:[0,1,0] neg_hi:[0,1,0]
  v_pk_fma_f32 v[86:87], v[30:31], v[14:15], v[86:87] op_sel_hi:[1,0,1] neg_lo:[0,1,0] neg_hi:[0,1,0]
  v_pk_mul_f32 v[84:85], v[84:85], v[14:15] op_sel:[0,1] op_sel_hi:[1,1]
  v_pk_mul_f32 v[86:87], v[86:87], v[14:15] op_sel:[0,1] op_sel_hi:[1,1]
  v_cvt_pk_bf16_f32 v36, v84, v85
  v_cvt_pk_bf16_f32 v37, v86, v87
  ds_write_b64 v33, v[36:37] offset:1024
  v_pk_fma_f32 v[88:89], v[28:29], v[16:17], v[88:89] op_sel_hi:[1,0,1] neg_lo:[0,1,0] neg_hi:[0,1,0]
  v_pk_fma_f32 v[90:91], v[30:31], v[16:17], v[90:91] op_sel_hi:[1,0,1] neg_lo:[0,1,0] neg_hi:[0,1,0]
  v_pk_mul_f32 v[88:89], v[88:89], v[16:17] op_sel:[0,1] op_sel_hi:[1,1]
  v_pk_mul_f32 v[90:91], v[90:91], v[16:17] op_sel:[0,1] op_sel_hi:[1,1]
  v_cvt_pk_bf16_f32 v38, v88, v89
  v_cvt_pk_bf16_f32 v39, v90, v91
  ds_write_b64 v33, v[38:39] offset:1536
  v_pk_fma_f32 v[92:93], v[28:29], v[18:19], v[92:93] op_sel_hi:[1,0,1] neg_lo:[0,1,0] neg_hi:[0,1,0]
  v_pk_fma_f32 v[94:95], v[30:31], v[18:19], v[94:95] op_sel_hi:[1,0,1] neg_lo:[0,1,0] neg_hi:[0,1,0]
  v_pk_mul_f32 v[92:93], v[92:93], v[18:19] op_sel:[0,1] op_sel_hi:[1,1]
  v_pk_mul_f32 v[94:95], v[94:95], v[18:19] op_sel:[0,1] op_sel_hi:[1,1]
  v_cvt_pk_bf16_f32 v36, v92, v93
  v_cvt_pk_bf16_f32 v37, v94, v95
  ds_write_b64 v33, v[36:37] offset:2048
  v_pk_fma_f32 v[96:97], v[28:29], v[20:21], v[96:97] op_sel_hi:[1,0,1] neg_lo:[0,1,0] neg_hi:[0,1,0]
  v_pk_fma_f32 v[98:99], v[30:31], v[20:21], v[98:99] op_sel_hi:[1,0,1] neg_lo:[0,1,0] neg_hi:[0,1,0]
  v_pk_mul_f32 v[96:97], v[96:97], v[20:21] op_sel:[0,1] op_sel_hi:[1,1]
  v_pk_mul_f32 v[98:99], v[98:99], v[20:21] op_sel:[0,1] op_sel_hi:[1,1]
  v_cvt_pk_bf16_f32 v38, v96, v97
  v_cvt_pk_bf16_f32 v39, v98, v99
  ds_write_b64 v33, v[38:39] offset:2560
  v_pk_fma_f32 v[100:101], v[28:29], v[22:23], v[100:101] op_sel_hi:[1,0,1] neg_lo:[0,1,0] neg_hi:[0,1,0]
  v_pk_fma_f32 v[102:103], v[30:31], v[22:23], v[102:103] op_sel_hi:[1,0,1] neg_lo:[0,1,0] neg_hi:[0,1,0]
  v_pk_mul_f32 v[100:101], v[100:101], v[22:23] op_sel:[0,1] op_sel_hi:[1,1]
  v_pk_mul_f32 v[102:103], v[102:103], v[22:23] op_sel:[0,1] op_sel_hi:[1,1]
  v_cvt_pk_bf16_f32 v36, v100, v101
  v_cvt_pk_bf16_f32 v37, v102, v103
  ds_write_b64 v33, v[36:37] offset:3072
  v_pk_fma_f32 v[104:105], v[28:29], v[24:25], v[104:105] op_sel_hi:[1,0,1] neg_lo:[0,1,0] neg_hi:[0,1,0]
  v_pk_fma_f32 v[106:107], v[30:31], v[24:25], v[106:107] op_sel_hi:[1,0,1] neg_lo:[0,1,0] neg_hi:[0,1,0]
  v_pk_mul_f32 v[104:105], v[104:105], v[24:25] op_sel:[0,1] op_sel_hi:[1,1]
  v_pk_mul_f32 v[106:107], v[106:107], v[24:25] op_sel:[0,1] op_sel_hi:[1,1]
  v_cvt_pk_bf16_f32 v38, v104, v105
  v_cvt_pk_bf16_f32 v39, v106, v107
  ds_write_b64 v33, v[38:39] offset:3584
  v_pk_fma_f32 v[108:109], v[28:29], v[26:27], v[108:109] op_sel_hi:[1,0,1] neg_lo:[0,1,0] neg_hi:[0,1,0]
  v_pk_fma_f32 v[110:111], v[30:31], v[26:27], v[110:111] op_sel_hi:[1,0,1] neg_lo:[0,1,0] neg_hi:[0,1,0]
  v_pk_mul_f32 v[108:109], v[108:109], v[26:27] op_sel:[0,1] op_sel_hi:[1,1]
  v_pk_mul_f32 v[110:111], v[110:111], v[26:27] op_sel:[0,1] op_sel_hi:[1,1]
  v_cvt_pk_bf16_f32 v36, v108, v109
  v_cvt_pk_bf16_f32 v37, v110, v111
  ds_write_b64 v33, v[36:37] offset:4096
  v_mov_b32_dpp v28, v112 row_newbcast:0 row_mask:0xf bank_mask:0xf
  v_mov_b32_dpp v29, v113 row_newbcast:0 row_mask:0xf bank_mask:0xf
  v_mov_b32_dpp v30, v114 row_newbcast:0 row_mask:0xf bank_mask:0xf
  v_mov_b32_dpp v31, v115 row_newbcast:0 row_mask:0xf bank_mask:0xf
  v_pk_fma_f32 v[112:113], v[28:29], v[10:11], v[112:113] op_sel_hi:[1,0,1] neg_lo:[0,1,0] neg_hi:[0,1,0]
  v_pk_fma_f32 v[114:115], v[30:31], v[10:11], v[114:115] op_sel_hi:[1,0,1] neg_lo:[0,1,0] neg_hi:[0,1,0]
  v_pk_mul_f32 v[112:113], v[112:113], v[10:11] op_sel:[0,1] op_sel_hi:[1,1]
  v_pk_mul_f32 v[114:115], v[114:115], v[10:11] op_sel:[0,1] op_sel_hi:[1,1]
  v_cvt_pk_bf16_f32 v36, v112, v113
  v_cvt_pk_bf16_f32 v37, v114, v115
  ds_write_b64 v34, v[36:37] offset:0
  v_pk_fma_f32 v[116:117], v[28:29], v[12:13], v[116:117] op_sel_hi:[1,0,1] neg_lo:[0,1,0] neg_hi:[0,1,0]
  v_pk_fma_f32 v[118:119], v[30:31], v[12:13], v[118:119] op_sel_hi:[1,0,1] neg_lo:[0,1,0] neg_hi:[0,1,0]
  v_pk_mul_f32 v[116:117], v[116:117], v[12:13] op_sel:[0,1] op_sel_hi:[1,1]
  v_pk_mul_f32 v[118:119], v[118:119], v[12:13] op_sel:[0,1] op_sel_hi:[1,1]
  v_cvt_pk_bf16_f32 v38, v116, v117
  v_cvt_pk_bf16_f32 v39, v118, v119
  ds_write_b64 v34, v[38:39] offset:512
  v_pk_fma_f32 v[120:121], v[28:29], v[14:15], v[120:121] op_sel_hi:[1,0,1] neg_lo:[0,1,0] neg_hi:[0,1,0]
  v_pk_fma_f32 v[122:123], v[30:31], v[14:15], v[122:123] op_sel_hi:[1,0,1] neg_lo:[0,1,0] neg_hi:[0,1,0]
  v_pk_mul_f32 v[120:121], v[120:121], v[14:15] op_sel:[0,1] op_sel_hi:[1,1]
  v_pk_mul_f32 v[122:123], v[122:123], v[14:15] op_sel:[0,1] op_sel_hi:[1,1]
  v_cvt_pk_bf16_f32 v36, v120, v121
  v_cvt_pk_bf16_f32 v37, v122, v123
  ds_write_b64 v34, v[36:37] offset:1024
  v_pk_fma_f32 v[124:125], v[28:29], v[16:17], v[124:125] op_sel_hi:[1,0,1] neg_lo:[0,1,0] neg_hi:[0,1,0]
  v_pk_fma_f32 v[126:127], v[30:31], v[16:17], v[126:127] op_sel_hi:[1,0,1] neg_lo:[0,1,0] neg_hi:[0,1,0]
  v_pk_mul_f32 v[124:125], v[124:125], v[16:17] op_sel:[0,1] op_sel_hi:[1,1]
  v_pk_mul_f32 v[126:127], v[126:127], v[16:17] op_sel:[0,1] op_sel_hi:[1,1]
  v_cvt_pk_bf16_f32 v38, v124, v125
  v_cvt_pk_bf16_f32 v39, v126, v127
  ds_write_b64 v34, v[38:39] offset:1536
  v_pk_fma_f32 v[128:129], v[28:29], v[18:19], v[128:129] op_sel_hi:[1,0,1] neg_lo:[0,1,0] neg_hi:[0,1,0]
  v_pk_fma_f32 v[130:131], v[30:31], v[18:19], v[130:131] op_sel_hi:[1,0,1] neg_lo:[0,1,0] neg_hi:[0,1,0]
  v_pk_mul_f32 v[128:129], v[128:129], v[18:19] op_sel:[0,1] op_sel_hi:[1,1]
  v_pk_mul_f32 v[130:131], v[130:131], v[18:19] op_sel:[0,1] op_sel_hi:[1,1]
  v_cvt_pk_bf16_f32 v36, v128, v129
  v_cvt_pk_bf16_f32 v37, v130, v131
  ds_write_b64 v34, v[36:37] offset:2048
  v_pk_fma_f32 v[132:133], v[28:29], v[20:21], v[132:133] op_sel_hi:[1,0,1] neg_lo:[0,1,0] neg_hi:[0,1,0]
  v_pk_fma_f32 v[134:135], v[30:31], v[20:21], v[134:135] op_sel_hi:[1,0,1] neg_lo:[0,1,0] neg_hi:[0,1,0]
  v_pk_mul_f32 v[132:133], v[132:133], v[20:21] op_sel:[0,1] op_sel_hi:[1,1]
  v_pk_mul_f32 v[134:135], v[134:135], v[20:21] op_sel:[0,1] op_sel_hi:[1,1]
  v_cvt_pk_bf16_f32 v38, v132, v133
  v_cvt_pk_bf16_f32 v39, v134, v135
  ds_write_b64 v34, v[38:39] offset:2560
  v_pk_fma_f32 v[136:137], v[28:29], v[22:23], v[136:137] op_sel_hi:[1,0,1] neg_lo:[0,1,0] neg_hi:[0,1,0]
  v_pk_fma_f32 v[138:139], v[30:31], v[22:23], v[138:139] op_sel_hi:[1,0,1] neg_lo:[0,1,0] neg_hi:[0,1,0]
  v_pk_mul_f32 v[136:137], v[136:137], v[22:23] op_sel:[0,1] op_sel_hi:[1,1]
  v_pk_mul_f32 v[138:139], v[138:139], v[22:23] op_sel:[0,1] op_sel_hi:[1,1]
  v_cvt_pk_bf16_f32 v36, v136, v137
  v_cvt_pk_bf16_f32 v37, v138, v139
  ds_write_b64 v34, v[36:37] offset:3072
  v_pk_fma_f32 v[140:141], v[28:29], v[24:25], v[140:141] op_sel_hi:[1,0,1] neg_lo:[0,1,0] neg_hi:[0,1,0]
  v_pk_fma_f32 v[142:143], v[30:31], v[24:25], v[142:143] op_sel_hi:[1,0,1] neg_lo:[0,1,0] neg_hi:[0,1,0]
  v_pk_mul_f32 v[140:141], v[140:141], v[24:25] op_sel:[0,1] op_sel_hi:[1,1]
  v_pk_mul_f32 v[142:143], v[142:143], v[24:25] op_sel:[0,1] op_sel_hi:[1,1]
  v_cvt_pk_bf16_f32 v38, v140, v141
  v_cvt_pk_bf16_f32 v39, v142, v143
  ds_write_b64 v34, v[38:39] offset:3584
  v_pk_fma_f32 v[144:145], v[28:29], v[26:27], v[144:145] op_sel_hi:[1,0,1] neg_lo:[0,1,0] neg_hi:[0,1,0]
  v_pk_fma_f32 v[146:147], v[30:31], v[26:27], v[146:147] op_sel_hi:[1,0,1] neg_lo:[0,1,0] neg_hi:[0,1,0]
  v_pk_mul_f32 v[144:145], v[144:145], v[26:27] op_sel:[0,1] op_sel_hi:[1,1]
  v_pk_mul_f32 v[146:147], v[146:147], v[26:27] op_sel:[0,1] op_sel_hi:[1,1]
  v_cvt_pk_bf16_f32 v36, v144, v145
  v_cvt_pk_bf16_f32 v37, v146, v147
  ds_write_b64 v34, v[36:37] offset:4096
  s_cmp_eq_u32 s40, 3
  s_cbranch_scc1 Lq3_56
  v_mov_b32_dpp v28, v148 row_newbcast:0 row_mask:0xf bank_mask:0xf
  v_mov_b32_dpp v29, v149 row_newbcast:0 row_mask:0xf bank_mask:0xf
  v_mov_b32_dpp v30, v150 row_newbcast:0 row_mask:0xf bank_mask:0xf
  v_mov_b32_dpp v31, v151 row_newbcast:0 row_mask:0xf bank_mask:0xf
  v_pk_fma_f32 v[148:149], v[28:29], v[10:11], v[148:149] op_sel_hi:[1,0,1] neg_lo:[0,1,0] neg_hi:[0,1,0]
  v_pk_fma_f32 v[150:151], v[30:31], v[10:11], v[150:151] op_sel_hi:[1,0,1] neg_lo:[0,1,0] neg_hi:[0,1,0]
  v_pk_mul_f32 v[148:149], v[148:149], v[10:11] op_sel:[0,1] op_sel_hi:[1,1]
  v_pk_mul_f32 v[150:151], v[150:151], v[10:11] op_sel:[0,1] op_sel_hi:[1,1]
  v_cvt_pk_bf16_f32 v36, v148, v149
  v_cvt_pk_bf16_f32 v37, v150, v151
  ds_write_b64 v35, v[36:37] offset:0
  v_pk_fma_f32 v[152:153], v[28:29], v[12:13], v[152:153] op_sel_hi:[1,0,1] neg_lo:[0,1,0] neg_hi:[0,1,0]
  v_pk_fma_f32 v[154:155], v[30:31], v[12:13], v[154:155] op_sel_hi:[1,0,1] neg_lo:[0,1,0] neg_hi:[0,1,0]
  v_pk_mul_f32 v[152:153], v[152:153], v[12:13] op_sel:[0,1] op_sel_hi:[1,1]
  v_pk_mul_f32 v[154:155], v[154:155], v[12:13] op_sel:[0,1] op_sel_hi:[1,1]
  v_cvt_pk_bf16_f32 v38, v152, v153
  v_cvt_pk_bf16_f32 v39, v154, v155
  ds_write_b64 v35, v[38:39] offset:512
  v_pk_fma_f32 v[156:157], v[28:29], v[14:15], v[156:157] op_sel_hi:[1,0,1] neg_lo:[0,1,0] neg_hi:[0,1,0]
  v_pk_fma_f32 v[158:159], v[30:31], v[14:15], v[158:159] op_sel_hi:[1,0,1] neg_lo:[0,1,0] neg_hi:[0,1,0]
  v_pk_mul_f32 v[156:157], v[156:157], v[14:15] op_sel:[0,1] op_sel_hi:[1,1]
  v_pk_mul_f32 v[158:159], v[158:159], v[14:15] op_sel:[0,1] op_sel_hi:[1,1]
  v_cvt_pk_bf16_f32 v36, v156, v157
  v_cvt_pk_bf16_f32 v37, v158, v159
  ds_write_b64 v35, v[36:37] offset:1024
  v_pk_fma_f32 v[160:161], v[28:29], v[16:17], v[160:161] op_sel_hi:[1,0,1] neg_lo:[0,1,0] neg_hi:[0,1,0]
  v_pk_fma_f32 v[162:163], v[30:31], v[16:17], v[162:163] op_sel_hi:[1,0,1] neg_lo:[0,1,0] neg_hi:[0,1,0]
  v_pk_mul_f32 v[160:161], v[160:161], v[16:17] op_sel:[0,1] op_sel_hi:[1,1]
  v_pk_mul_f32 v[162:163], v[162:163], v[16:17] op_sel:[0,1] op_sel_hi:[1,1]
  v_cvt_pk_bf16_f32 v38, v160, v161
  v_cvt_pk_bf16_f32 v39, v162, v163
  ds_write_b64 v35, v[38:39] offset:1536
  v_pk_fma_f32 v[164:165], v[28:29], v[18:19], v[164:165] op_sel_hi:[1,0,1] neg_lo:[0,1,0] neg_hi:[0,1,0]
  v_pk_fma_f32 v[166:167], v[30:31], v[18:19], v[166:167] op_sel_hi:[1,0,1] neg_lo:[0,1,0] neg_hi:[0,1,0]
  v_pk_mul_f32 v[164:165], v[164:165], v[18:19] op_sel:[0,1] op_sel_hi:[1,1]
  v_pk_mul_f32 v[166:167], v[166:167], v[18:19] op_sel:[0,1] op_sel_hi:[1,1]
  v_cvt_pk_bf16_f32 v36, v164, v165
  v_cvt_pk_bf16_f32 v37, v166, v167
  ds_write_b64 v35, v[36:37] offset:2048
  v_pk_fma_f32 v[168:169], v[28:29], v[20:21], v[168:169] op_sel_hi:[1,0,1] neg_lo:[0,1,0] neg_hi:[0,1,0]
  v_pk_fma_f32 v[170:171], v[30:31], v[20:21], v[170:171] op_sel_hi:[1,0,1] neg_lo:[0,1,0] neg_hi:[0,1,0]
  v_pk_mul_f32 v[168:169], v[168:169], v[20:21] op_sel:[0,1] op_sel_hi:[1,1]
  v_pk_mul_f32 v[170:171], v[170:171], v[20:21] op_sel:[0,1] op_sel_hi:[1,1]
  v_cvt_pk_bf16_f32 v38, v168, v169
  v_cvt_pk_bf16_f32 v39, v170, v171
  ds_write_b64 v35, v[38:39] offset:2560
  v_pk_fma_f32 v[172:173], v[28:29], v[22:23], v[172:173] op_sel_hi:[1,0,1] neg_lo:[0,1,0] neg_hi:[0,1,0]
  v_pk_fma_f32 v[174:175], v[30:31], v[22:23], v[174:175] op_sel_hi:[1,0,1] neg_lo:[0,1,0] neg_hi:[0,1,0]
  v_pk_mul_f32 v[172:173], v[172:173], v[22:23] op_sel:[0,1] op_sel_hi:[1,1]
  v_pk_mul_f32 v[174:175], v[174:175], v[22:23] op_sel:[0,1] op_sel_hi:[1,1]
  v_cvt_pk_bf16_f32 v36, v172, v173
  v_cvt_pk_bf16_f32 v37, v174, v175
  ds_write_b64 v35, v[36:37] offset:3072
  v_pk_fma_f32 v[176:177], v[28:29], v[24:25], v[176:177] op_sel_hi:[1,0,1] neg_lo:[0,1,0] neg_hi:[0,1,0]
  v_pk_fma_f32 v[178:179], v[30:31], v[24:25], v[178:179] op_sel_hi:[1,0,1] neg_lo:[0,1,0] neg_hi:[0,1,0]
  v_pk_mul_f32 v[176:177], v[176:177], v[24:25] op_sel:[0,1] op_sel_hi:[1,1]
  v_pk_mul_f32 v[178:179], v[178:179], v[24:25] op_sel:[0,1] op_sel_hi:[1,1]
  v_cvt_pk_bf16_f32 v38, v176, v177
  v_cvt_pk_bf16_f32 v39, v178, v179
  ds_write_b64 v35, v[38:39] offset:3584
  v_pk_fma_f32 v[180:181], v[28:29], v[26:27], v[180:181] op_sel_hi:[1,0,1] neg_lo:[0,1,0] neg_hi:[0,1,0]
  v_pk_fma_f32 v[182:183], v[30:31], v[26:27], v[182:183] op_sel_hi:[1,0,1] neg_lo:[0,1,0] neg_hi:[0,1,0]
  v_pk_mul_f32 v[180:181], v[180:181], v[26:27] op_sel:[0,1] op_sel_hi:[1,1]
  v_pk_mul_f32 v[182:183], v[182:183], v[26:27] op_sel:[0,1] op_sel_hi:[1,1]
  v_cvt_pk_bf16_f32 v36, v180, v181
  v_cvt_pk_bf16_f32 v37, v182, v183
  ds_write_b64 v35, v[36:37] offset:4096
Lq3_56:
  s_waitcnt lgkmcnt(0)
  s_branch LA_att
LA_loader:
  s_cmp_ge_u32 s41, 2
  s_cbranch_scc1 LA_loaderB
  v_lshrrev_b32 v2, 3, v1
  s_and_b32 s44, s41, 1
  s_lshl_b32 s44, s44, 2
  v_lshrrev_b32 v3, 1, v2
  v_or_b32 v3, s44, v3
  v_and_b32 v4, 7, v1
  v_xor_b32 v3, v3, v4
  v_lshlrev_b32 v3, 4, v3
  v_mov_b32 v5, 0x7ff00000
  s_add_u32 s44, s41, 0
  s_lshl_b32 s44, s44, 3
  s_lshl_b32 s45, s43, 7
  s_add_i32 s44, s44, s45
  s_add_i32 s44, s44, -16
  v_add_u32 v4, s44, v2
  v_mul_i32_i24 v10, 1280, v4
  v_add_u32 v10, v10, v3
  v_cmp_gt_i32 vcc, 0, v4
  s_nop 1
  v_cndmask_b32 v10, v10, v5, vcc
  s_add_u32 s44, s41, 4
  s_lshl_b32 s44, s44, 3
  s_lshl_b32 s45, s43, 7
  s_add_i32 s44, s44, s45
  s_add_i32 s44, s44, -16
  v_add_u32 v4, s44, v2
  v_mul_i32_i24 v11, 1280, v4
  v_add_u32 v11, v11, v3
  v_cmp_gt_i32 vcc, 0, v4
  s_nop 1
  v_cndmask_b32 v11, v11, v5, vcc
  s_add_u32 s44, s41, 8
  s_lshl_b32 s44, s44, 3
  s_lshl_b32 s45, s43, 7
  s_add_i32 s44, s44, s45
  s_add_i32 s44, s44, -16
  v_add_u32 v4, s44, v2
  v_mul_i32_i24 v12, 1280, v4
  v_add_u32 v12, v12, v3
  v_cmp_gt_i32 vcc, 0, v4
  s_nop 1
  v_cndmask_b32 v12, v12, v5, vcc
  s_add_u32 s44, s41, 12
  s_lshl_b32 s44, s44, 3
  s_lshl_b32 s45, s43, 7
  s_add_i32 s44, s44, s45
  s_add_i32 s44, s44, -16
  v_add_u32 v4, s44, v2
  v_mul_i32_i24 v13, 1280, v4
  v_add_u32 v13, v13, v3
  v_cmp_gt_i32 vcc, 0, v4
  s_nop 1
  v_cndmask_b32 v13, v13, v5, vcc
  s_add_u32 s44, s41, 16
  s_lshl_b32 s44, s44, 3
  s_lshl_b32 s45, s43, 7
  s_add_i32 s44, s44, s45
  s_add_i32 s44, s44, -16
  v_add_u32 v4, s44, v2
  v_mul_i32_i24 v14, 1280, v4
  v_add_u32 v14, v14, v3
  v_cmp_gt_i32 vcc, 0, v4
  s_nop 1
  v_cndmask_b32 v14, v14, v5, vcc
  s_add_i32 s44, s41, 2
  s_lshl_b32 s44, s44, 6
  v_add_u32 v2, s44, v1
  v_mul_u32_u24 v3, 2185, v2
  v_lshrrev_b32 v3, 16, v3
  v_mul_u32_u24 v4, 30, v3
  v_sub_u32 v2, v2, v4
  v_and_b32 v4, 0x33, v3
  v_bfe_u32 v5, v3, 2, 1
  v_lshl_or_b32 v4, v5, 3, v4
  v_bfe_u32 v5, v3, 3, 1
  v_lshl_or_b32 v4, v5, 2, v4
  v_mul_u32_u24 v15, 3840, v4
  v_mul_u32_u24 v3, 26, v2
  v_lshrrev_b32 v3, 8, v3
  v_mul_u32_u24 v4, 1120, v3
  v_lshl_add_u32 v4, v2, 4, v4
  s_mul_i32 s44, s42, 160
  v_add3_u32 v15, v15, v4, s44
  s_add_i32 s44, s41, 6
  s_lshl_b32 s44, s44, 6
  v_add_u32 v2, s44, v1
  v_mul_u32_u24 v3, 2185, v2
  v_lshrrev_b32 v3, 16, v3
  v_mul_u32_u24 v4, 30, v3
  v_sub_u32 v2, v2, v4
  v_and_b32 v4, 0x33, v3
  v_bfe_u32 v5, v3, 2, 1
  v_lshl_or_b32 v4, v5, 3, v4
  v_bfe_u32 v5, v3, 3, 1
  v_lshl_or_b32 v4, v5, 2, v4
  v_mul_u32_u24 v16, 3840, v4
  v_mul_u32_u24 v3, 26, v2
  v_lshrrev_b32 v3, 8, v3
  v_mul_u32_u24 v4, 1120, v3
  v_lshl_add_u32 v4, v2, 4, v4
  s_mul_i32 s44, s42, 160
  v_add3_u32 v16, v16, v4, s44
  s_add_i32 s44, s41, 10
  s_lshl_b32 s44, s44, 6
  v_add_u32 v2, s44, v1
  v_mul_u32_u24 v3, 2185, v2
  v_lshrrev_b32 v3, 16, v3
  v_mul_u32_u24 v4, 30, v3
  v_sub_u32 v2, v2, v4
  v_and_b32 v4, 0x33, v3
  v_bfe_u32 v5, v3, 2, 1
  v_lshl_or_b32 v4, v5, 3, v4
  v_bfe_u32 v5, v3, 3, 1
  v_lshl_or_b32 v4, v5, 2, v4
  v_mul_u32_u24 v17, 3840, v4
  v_mul_u32_u24 v3, 26, v2
  v_lshrrev_b32 v3, 8, v3
  v_mul_u32_u24 v4, 1120, v3
  v_lshl_add_u32 v4, v2, 4, v4
  s_mul_i32 s44, s42, 160
  v_add3_u32 v17, v17, v4, s44
  s_add_i32 s44, s41, 14
  s_lshl_b32 s44, s44, 6
  v_add_u32 v2, s44, v1
  v_mul_u32_u24 v3, 2185, v2
  v_lshrrev_b32 v3, 16, v3
  v_mul_u32_u24 v4, 30, v3
  v_sub_u32 v2, v2, v4
  v_and_b32 v4, 0x33, v3
  v_bfe_u32 v5, v3, 2, 1
  v_lshl_or_b32 v4, v5, 3, v4
  v_bfe_u32 v5, v3, 3, 1
  v_lshl_or_b32 v4, v5, 2, v4
  v_mul_u32_u24 v18, 3840, v4
  v_mul_u32_u24 v3, 26, v2
  v_lshrrev_b32 v3, 8, v3
  v_mul_u32_u24 v4, 1120, v3
  v_lshl_add_u32 v4, v2, 4, v4
  s_mul_i32 s44, s42, 160
  v_add3_u32 v18, v18, v4, s44
  s_add_i32 s44, s41, 18
  s_lshl_b32 s44, s44, 6
  v_add_u32 v2, s44, v1
  v_mul_u32_u24 v3, 2185, v2
  v_lshrrev_b32 v3, 16, v3
  v_mul_u32_u24 v4, 30, v3
  v_sub_u32 v2, v2, v4
  v_and_b32 v4, 0x33, v3
  v_bfe_u32 v5, v3, 2, 1
  v_lshl_or_b32 v4, v5, 3, v4
  v_bfe_u32 v5, v3, 3, 1
  v_lshl_or_b32 v4, v5, 2, v4
  v_mul_u32_u24 v19, 3840, v4
  v_mul_u32_u24 v3, 26, v2
  v_lshrrev_b32 v3, 8, v3
  v_mul_u32_u24 v4, 1120, v3
  v_lshl_add_u32 v4, v2, 4, v4
  s_mul_i32 s44, s42, 160
  v_add3_u32 v19, v19, v4, s44
  s_add_i32 s44, s41, 22
  s_lshl_b32 s44, s44, 6
  v_add_u32 v2, s44, v1
  v_mul_u32_u24 v3, 2185, v2
  v_lshrrev_b32 v3, 16, v3
  v_mul_u32_u24 v4, 30, v3
  v_sub_u32 v2, v2, v4
  v_and_b32 v4, 0x33, v3
  v_bfe_u32 v5, v3, 2, 1
  v_lshl_or_b32 v4, v5, 3, v4
  v_bfe_u32 v5, v3, 3, 1
  v_lshl_or_b32 v4, v5, 2, v4
  v_mul_u32_u24 v20, 3840, v4
  v_mul_u32_u24 v3, 26, v2
  v_lshrrev_b32 v3, 8, v3
  v_mul_u32_u24 v4, 1120, v3
  v_lshl_add_u32 v4, v2, 4, v4
  s_mul_i32 s44, s42, 160
  v_add3_u32 v20, v20, v4, s44
  s_add_i32 s44, s41, 26
  s_lshl_b32 s44, s44, 6
  v_add_u32 v2, s44, v1
  v_mul_u32_u24 v3, 2185, v2
  v_lshrrev_b32 v3, 16, v3
  v_mul_u32_u24 v4, 30, v3
  v_sub_u32 v2, v2, v4
  v_and_b32 v4, 0x33, v3
  v_bfe_u32 v5, v3, 2, 1
  v_lshl_or_b32 v4, v5, 3, v4
  v_bfe_u32 v5, v3, 3, 1
  v_lshl_or_b32 v4, v5, 2, v4
  v_mul_u32_u24 v21, 3840, v4
  v_mul_u32_u24 v3, 26, v2
  v_lshrrev_b32 v3, 8, v3
  v_mul_u32_u24 v4, 1120, v3
  v_lshl_add_u32 v4, v2, 4, v4
  s_mul_i32 s44, s42, 160
  v_add3_u32 v21, v21, v4, s44
  s_cmp_eq_u32 s41, 0
  s_cselect_b32 s56, 0xffffff00, -1
  s_mov_b32 s57, -1
  s_lshl_b32 s51, s41, 10
  s_mov_b32 s52, s51
  s_add_u32 s53, s51, 147456
  s_mul_i32 s49, s38, 128
  s_mul_i32 s50, s38, 245760
  s_mov_b32 s47, 2
Lpro_57:
  s_add_u32 m0, s51, 0
  s_mov_b64 exec, s[56:57]
  buffer_load_dwordx4 v10, s[60:63], s49 offen  lds
  s_mov_b64 exec, -1
  s_add_u32 m0, s51, 4096
  s_nop 0
  buffer_load_dwordx4 v11, s[60:63], s49 offen  lds
  s_add_u32 m0, s51, 8192
  s_nop 0
  buffer_load_dwordx4 v12, s[60:63], s49 offen  lds
  s_add_u32 m0, s51, 12288
  s_nop 0
  buffer_load_dwordx4 v13, s[60:63], s49 offen  lds
  s_add_u32 m0, s51, 16384
  s_nop 0
  buffer_load_dwordx4 v14, s[60:63], s49 offen  lds
  s_add_u32 m0, s51, 20480
  s_nop 0
  buffer_load_dwordx4 v15, s[64:67], s50 offen  lds
  s_add_u32 m0, s51, 24576
  s_nop 0
  buffer_load_dwordx4 v16, s[64:67], s50 offen  lds
  s_add_u32 m0, s51, 28672
  s_nop 0
  buffer_load_dwordx4 v17, s[64:67], s50 offen  lds
  s_add_u32 m0, s51, 32768
  s_nop 0
  buffer_load_dwordx4 v18, s[64:67], s50 offen  lds
  s_add_u32 m0, s51, 36864
  s_nop 0
  buffer_load_dwordx4 v19, s[64:67], s50 offen  lds
  s_add_u32 m0, s51, 40960
  s_nop 0
  buffer_load_dwordx4 v20, s[64:67], s50 offen  lds
  s_add_u32 m0, s51, 45056
  s_nop 0
  buffer_load_dwordx4 v21, s[64:67], s50 offen  lds
  s_add_u32 s49, s49, 128
  s_cmp_eq_u32 s49, 1280
  s_cselect_b32 s49, 0, s49
  s_add_u32 s50, s50, 245760
  s_cmp_eq_u32 s50, 2457600
  s_cselect_b32 s50, 0, s50
  s_add_u32 s51, s51, 49152
  s_cmp_eq_u32 s51, s53
  s_cselect_b32 s51, s52, s51
  s_sub_u32 s47, s47, 1
  s_cmp_lg_u32 s47, 0
  s_cbranch_scc1 Lpro_57
  s_mov_b32 m0, s51
  s_mov_b32 s47, 8
  s_waitcnt vmcnt(12)
  s_barrier
  s_mov_b64 exec, s[56:57]
  buffer_load_dwordx4 v10, s[60:63], s49 offen  lds
  s_mov_b64 exec, -1
  s_add_u32 m0, s51, 4096
  s_add_u32 s46, s50, 245760
  s_cmp_eq_u32 s46, 2457600
  s_cselect_b32 s46, 0, s46
Lld_58:
  buffer_load_dwordx4 v11, s[60:63], s49 offen  lds
  s_add_u32 m0, s51, 8192
  s_nop 0
  buffer_load_dwordx4 v12, s[60:63], s49 offen  lds
  s_add_u32 m0, s51, 12288
  s_nop 0
  buffer_load_dwordx4 v13, s[60:63], s49 offen  lds
  s_add_u32 m0, s51, 16384
  s_nop 0
  buffer_load_dwordx4 v14, s[60:63], s49 offen  lds
  s_add_u32 m0, s51, 20480
  s_add_u32 s49, s49, 128
  s_cmp_eq_u32 s49, 1280
  s_cselect_b32 s49, 0, s49
  buffer_load_dwordx4 v15, s[64:67], s50 offen  lds
  s_add_u32 m0, s51, 24576
  s_nop 0
  buffer_load_dwordx4 v16, s[64:67], s50 offen  lds
  s_add_u32 m0, s51, 28672
  s_nop 0
  buffer_load_dwordx4 v17, s[64:67], s50 offen  lds
  s_add_u32 m0, s51, 32768
  s_nop 0
  buffer_load_dwordx4 v18, s[64:67], s50 offen  lds
  s_add_u32 m0, s51, 36864
  s_nop 0
  buffer_load_dwordx4 v19, s[64:67], s50 offen  lds
  s_add_u32 m0, s51, 40960
  s_nop 0
  buffer_load_dwordx4 v20, s[64:67], s50 offen  lds
  s_add_u32 m0, s51, 45056
  s_add_u32 s51, s51, 49152
  s_cmp_eq_u32 s51, s53
  s_cselect_b32 s51, s52, s51
  s_sub_u32 s47, s47, 1
  s_cmp_lg_u32 s47, 0
  buffer_load_dwordx4 v21, s[64:67], s50 offen  lds
  s_mov_b32 s50, s46
  s_mov_b32 m0, s51
  s_cbranch_scc0 Lldx_59
  s_waitcnt vmcnt(12)
  s_barrier
  s_mov_b64 exec, s[56:57]
  buffer_load_dwordx4 v10, s[60:63], s49 offen  lds
  s_mov_b64 exec, -1
  s_add_u32 m0, s51, 4096
  s_add_u32 s46, s50, 245760
  s_cmp_eq_u32 s46, 2457600
  s_cselect_b32 s46, 0, s46
  s_branch Lld_58
Lldx_59:
  s_waitcnt vmcnt(12)
  s_barrier
  s_waitcnt vmcnt(0)
  s_barrier
  s_barrier
  s_branch LA_pad
LA_loaderB:
  v_lshrrev_b32 v2, 3, v1
  s_and_b32 s44, s41, 1
  s_lshl_b32 s44, s44, 2
  v_lshrrev_b32 v3, 1, v2
  v_or_b32 v3, s44, v3
  v_and_b32 v4, 7, v1
  v_xor_b32 v3, v3, v4
  v_lshlrev_b32 v3, 4, v3
  v_mov_b32 v5, 0x7ff00000
  s_add_u32 s44, s41, 0
  s_lshl_b32 s44, s44, 3
  s_lshl_b32 s45, s43, 7
  s_add_i32 s44, s44, s45
  s_add_i32 s44, s44, -16
  v_add_u32 v4, s44, v2
  v_mul_i32_i24 v10, 1280, v4
  v_add_u32 v10, v10, v3
  v_cmp_gt_i32 vcc, 0, v4
  s_nop 1
  v_cndmask_b32 v10, v10, v5, vcc
  s_add_u32 s44, s41, 4
  s_lshl_b32 s44, s44, 3
  s_lshl_b32 s45, s43, 7
  s_add_i32 s44, s44, s45
  s_add_i32 s44, s44, -16
  v_add_u32 v4, s44, v2
  v_mul_i32_i24 v11, 1280, v4
  v_add_u32 v11, v11, v3
  v_cmp_gt_i32 vcc, 0, v4
  s_nop 1
  v_cndmask_b32 v11, v11, v5, vcc
  s_add_u32 s44, s41, 8
  s_lshl_b32 s44, s44, 3
  s_lshl_b32 s45, s43, 7
  s_add_i32 s44, s44, s45
  s_add_i32 s44, s44, -16
  v_add_u32 v4, s44, v2
  v_mul_i32_i24 v12, 1280, v4
  v_add_u32 v12, v12, v3
  v_cmp_gt_i32 vcc, 0, v4
  s_nop 1
  v_cndmask_b32 v12, v12, v5, vcc
  s_add_u32 s44, s41, 12
  s_lshl_b32 s44, s44, 3
  s_lshl_b32 s45, s43, 7
  s_add_i32 s44, s44, s45
  s_add_i32 s44, s44, -16
  v_add_u32 v4, s44, v2
  v_mul_i32_i24 v13, 1280, v4
  v_add_u32 v13, v13, v3
  v_cmp_gt_i32 vcc, 0, v4
  s_nop 1
  v_cndmask_b32 v13, v13, v5, vcc
  s_add_i32 s44, s41, -2
  s_lshl_b32 s44, s44, 6
  v_add_u32 v2, s44, v1
  v_mul_u32_u24 v3, 2185, v2
  v_lshrrev_b32 v3, 16, v3
  v_mul_u32_u24 v4, 30, v3
  v_sub_u32 v2, v2, v4
  v_and_b32 v4, 0x33, v3
  v_bfe_u32 v5, v3, 2, 1
  v_lshl_or_b32 v4, v5, 3, v4
  v_bfe_u32 v5, v3, 3, 1
  v_lshl_or_b32 v4, v5, 2, v4
  v_mul_u32_u24 v14, 3840, v4
  v_mul_u32_u24 v3, 26, v2
  v_lshrrev_b32 v3, 8, v3
  v_mul_u32_u24 v4, 1120, v3
  v_lshl_add_u32 v4, v2, 4, v4
  s_mul_i32 s44, s42, 160
  v_add3_u32 v14, v14, v4, s44
  s_add_i32 s44, s41, 2
  s_lshl_b32 s44, s44, 6
  v_add_u32 v2, s44, v1
  v_mul_u32_u24 v3, 2185, v2
  v_lshrrev_b32 v3, 16, v3
  v_mul_u32_u24 v4, 30, v3
  v_sub_u32 v2, v2, v4
  v_and_b32 v4, 0x33, v3
  v_bfe_u32 v5, v3, 2, 1
  v_lshl_or_b32 v4, v5, 3, v4
  v_bfe_u32 v5, v3, 3, 1
  v_lshl_or_b32 v4, v5, 2, v4
  v_mul_u32_u24 v15, 3840, v4
  v_mul_u32_u24 v3, 26, v2
  v_lshrrev_b32 v3, 8, v3
  v_mul_u32_u24 v4, 1120, v3
  v_lshl_add_u32 v4, v2, 4, v4
  s_mul_i32 s44, s42, 160
  v_add3_u32 v15, v15, v4, s44
  s_add_i32 s44, s41, 6
  s_lshl_b32 s44, s44, 6
  v_add_u32 v2, s44, v1
  v_mul_u32_u24 v3, 2185, v2
  v_lshrrev_b32 v3, 16, v3
  v_mul_u32_u24 v4, 30, v3
  v_sub_u32 v2, v2, v4
  v_and_b32 v4, 0x33, v3
  v_bfe_u32 v5, v3, 2, 1
  v_lshl_or_b32 v4, v5, 3, v4
  v_bfe_u32 v5, v3, 3, 1
  v_lshl_or_b32 v4, v5, 2, v4
  v_mul_u32_u24 v16, 3840, v4
  v_mul_u32_u24 v3, 26, v2
  v_lshrrev_b32 v3, 8, v3
  v_mul_u32_u24 v4, 1120, v3
  v_lshl_add_u32 v4, v2, 4, v4
  s_mul_i32 s44, s42, 160
  v_add3_u32 v16, v16, v4, s44
  s_add_i32 s44, s41, 10
  s_lshl_b32 s44, s44, 6
  v_add_u32 v2, s44, v1
  v_mul_u32_u24 v3, 2185, v2
  v_lshrrev_b32 v3, 16, v3
  v_mul_u32_u24 v4, 30, v3
  v_sub_u32 v2, v2, v4
  v_and_b32 v4, 0x33, v3
  v_bfe_u32 v5, v3, 2, 1
  v_lshl_or_b32 v4, v5, 3, v4
  v_bfe_u32 v5, v3, 3, 1
  v_lshl_or_b32 v4, v5, 2, v4
  v_mul_u32_u24 v17, 3840, v4
  v_mul_u32_u24 v3, 26, v2
  v_lshrrev_b32 v3, 8, v3
  v_mul_u32_u24 v4, 1120, v3
  v_lshl_add_u32 v4, v2, 4, v4
  s_mul_i32 s44, s42, 160
  v_add3_u32 v17, v17, v4, s44
  s_add_i32 s44, s41, 14
  s_lshl_b32 s44, s44, 6
  v_add_u32 v2, s44, v1
  v_mul_u32_u24 v3, 2185, v2
  v_lshrrev_b32 v3, 16, v3
  v_mul_u32_u24 v4, 30, v3
  v_sub_u32 v2, v2, v4
  v_and_b32 v4, 0x33, v3
  v_bfe_u32 v5, v3, 2, 1
  v_lshl_or_b32 v4, v5, 3, v4
  v_bfe_u32 v5, v3, 3, 1
  v_lshl_or_b32 v4, v5, 2, v4
  v_mul_u32_u24 v18, 3840, v4
  v_mul_u32_u24 v3, 26, v2
  v_lshrrev_b32 v3, 8, v3
  v_mul_u32_u24 v4, 1120, v3
  v_lshl_add_u32 v4, v2, 4, v4
  s_mul_i32 s44, s42, 160
  v_add3_u32 v18, v18, v4, s44
  s_add_i32 s44, s41, 18
  s_lshl_b32 s44, s44, 6
  v_add_u32 v2, s44, v1
  v_mul_u32_u24 v3, 2185, v2
  v_lshrrev_b32 v3, 16, v3
  v_mul_u32_u24 v4, 30, v3
  v_sub_u32 v2, v2, v4
  v_and_b32 v4, 0x33, v3
  v_bfe_u32 v5, v3, 2, 1
  v_lshl_or_b32 v4, v5, 3, v4
  v_bfe_u32 v5, v3, 3, 1
  v_lshl_or_b32 v4, v5, 2, v4
  v_mul_u32_u24 v19, 3840, v4
  v_mul_u32_u24 v3, 26, v2
  v_lshrrev_b32 v3, 8, v3
  v_mul_u32_u24 v4, 1120, v3
  v_lshl_add_u32 v4, v2, 4, v4
  s_mul_i32 s44, s42, 160
  v_add3_u32 v19, v19, v4, s44
  s_add_i32 s44, s41, 22
  s_lshl_b32 s44, s44, 6
  v_add_u32 v2, s44, v1
  v_mul_u32_u24 v3, 2185, v2
  v_lshrrev_b32 v3, 16, v3
  v_mul_u32_u24 v4, 30, v3
  v_sub_u32 v2, v2, v4
  v_and_b32 v4, 0x33, v3
  v_bfe_u32 v5, v3, 2, 1
  v_lshl_or_b32 v4, v5, 3, v4
  v_bfe_u32 v5, v3, 3, 1
  v_lshl_or_b32 v4, v5, 2, v4
  v_mul_u32_u24 v20, 3840, v4
  v_mul_u32_u24 v3, 26, v2
  v_lshrrev_b32 v3, 8, v3
  v_mul_u32_u24 v4, 1120, v3
  v_lshl_add_u32 v4, v2, 4, v4
  s_mul_i32 s44, s42, 160
  v_add3_u32 v20, v20, v4, s44
  s_add_i32 s44, s41, 26
  s_lshl_b32 s44, s44, 6
  v_add_u32 v2, s44, v1
  v_mul_u32_u24 v3, 2185, v2
  v_lshrrev_b32 v3, 16, v3
  v_mul_u32_u24 v4, 30, v3
  v_sub_u32 v2, v2, v4
  v_and_b32 v4, 0x33, v3
  v_bfe_u32 v5, v3, 2, 1
  v_lshl_or_b32 v4, v5, 3, v4
  v_bfe_u32 v5, v3, 3, 1
  v_lshl_or_b32 v4, v5, 2, v4
  v_mul_u32_u24 v21, 3840, v4
  v_mul_u32_u24 v3, 26, v2
  v_lshrrev_b32 v3, 8, v3
  v_mul_u32_u24 v4, 1120, v3
  v_lshl_add_u32 v4, v2, 4, v4
  s_mul_i32 s44, s42, 160
  v_add3_u32 v21, v21, v4, s44
  s_cmp_eq_u32 s41, 0
  s_cselect_b32 s56, 0xffffff00, -1
  s_mov_b32 s57, -1
  s_lshl_b32 s51, s41, 10
  s_mov_b32 s52, s51
  s_add_u32 s53, s51, 147456
  s_mul_i32 s49, s38, 128
  s_mul_i32 s50, s38, 245760
  s_mov_b32 s47, 2
Lpro_60:
  s_add_u32 m0, s51, 0
  s_mov_b64 exec, s[56:57]
  buffer_load_dwordx4 v10, s[60:63], s49 offen  lds
  s_mov_b64 exec, -1
  s_add_u32 m0, s51, 4096
  s_nop 0
  buffer_load_dwordx4 v11, s[60:63], s49 offen  lds
  s_add_u32 m0, s51, 8192
  s_nop 0
  buffer_load_dwordx4 v12, s[60:63], s49 offen  lds
  s_add_u32 m0, s51, 12288
  s_nop 0
  buffer_load_dwordx4 v13, s[60:63], s49 offen  lds
  s_add_u32 m0, s51, 16384
  s_nop 0
  buffer_load_dwordx4 v14, s[64:67], s50 offen  lds
  s_add_u32 m0, s51, 20480
  s_nop 0
  buffer_load_dwordx4 v15, s[64:67], s50 offen  lds
  s_add_u32 m0, s51, 24576
  s_nop 0
  buffer_load_dwordx4 v16, s[64:67], s50 offen  lds
  s_add_u32 m0, s51, 28672
  s_nop 0
  buffer_load_dwordx4 v17, s[64:67], s50 offen  lds
  s_add_u32 m0, s51, 32768
  s_nop 0
  buffer_load_dwordx4 v18, s[64:67], s50 offen  lds
  s_add_u32 m0, s51, 36864
  s_nop 0
  buffer_load_dwordx4 v19, s[64:67], s50 offen  lds
  s_add_u32 m0, s51, 40960
  s_nop 0
  buffer_load_dwordx4 v20, s[64:67], s50 offen  lds
  s_add_u32 m0, s51, 45056
  s_nop 0
  buffer_load_dwordx4 v21, s[64:67], s50 offen  lds
  s_add_u32 s49, s49, 128
  s_cmp_eq_u32 s49, 1280
  s_cselect_b32 s49, 0, s49
  s_add_u32 s50, s50, 245760
  s_cmp_eq_u32 s50, 2457600
  s_cselect_b32 s50, 0, s50
  s_add_u32 s51, s51, 49152
  s_cmp_eq_u32 s51, s53
  s_cselect_b32 s51, s52, s51
  s_sub_u32 s47, s47, 1
  s_cmp_lg_u32 s47, 0
  s_cbranch_scc1 Lpro_60
  s_mov_b32 m0, s51
  s_mov_b32 s47, 8
  s_waitcnt vmcnt(12)
  s_barrier
  s_mov_b64 exec, s[56:57]
  buffer_load_dwordx4 v10, s[60:63], s49 offen  lds
  s_mov_b64 exec, -1
  s_add_u32 m0, s51, 4096
  s_add_u32 s46, s50, 245760
  s_cmp_eq_u32 s46, 2457600
  s_cselect_b32 s46, 0, s46
Lld_61:
  buffer_load_dwordx4 v11, s[60:63], s49 offen  lds
  s_add_u32 m0, s51, 8192
  s_nop 0
  buffer_load_dwordx4 v12, s[60:63], s49 offen  lds
  s_add_u32 m0, s51, 12288
  s_nop 0
  buffer_load_dwordx4 v13, s[60:63], s49 offen  lds
  s_add_u32 m0, s51, 16384
  s_add_u32 s49, s49, 128
  s_cmp_eq_u32 s49, 1280
  s_cselect_b32 s49, 0, s49
  buffer_load_dwordx4 v14, s[64:67], s50 offen  lds
  s_add_u32 m0, s51, 20480
  s_nop 0
  buffer_load_dwordx4 v15, s[64:67], s50 offen  lds
  s_add_u32 m0, s51, 24576
  s_nop 0
  buffer_load_dwordx4 v16, s[64:67], s50 offen  lds
  s_add_u32 m0, s51, 28672
  s_nop 0
  buffer_load_dwordx4 v17, s[64:67], s50 offen  lds
  s_add_u32 m0, s51, 32768
  s_nop 0
  buffer_load_dwordx4 v18, s[64:67], s50 offen  lds
  s_add_u32 m0, s51, 36864
  s_nop 0
  buffer_load_dwordx4 v19, s[64:67], s50 offen  lds
  s_add_u32 m0, s51, 40960
  s_nop 0
  buffer_load_dwordx4 v20, s[64:67], s50 offen  lds
  s_add_u32 m0, s51, 45056
  s_add_u32 s51, s51, 49152
  s_cmp_eq_u32 s51, s53
  s_cselect_b32 s51, s52, s51
  s_sub_u32 s47, s47, 1
  s_cmp_lg_u32 s47, 0
  buffer_load_dwordx4 v21, s[64:67], s50 offen  lds
  s_mov_b32 s50, s46
  s_mov_b32 m0, s51
  s_cbranch_scc0 Lldx_62
  s_waitcnt vmcnt(12)
  s_barrier
  s_mov_b64 exec, s[56:57]
  buffer_load_dwordx4 v10, s[60:63], s49 offen  lds
  s_mov_b64 exec, -1
  s_add_u32 m0, s51, 4096
  s_add_u32 s46, s50, 245760
  s_cmp_eq_u32 s46, 2457600
  s_cselect_b32 s46, 0, s46
  s_branch Lld_61
Lldx_62:
  s_waitcnt vmcnt(12)
  s_barrier
  s_waitcnt vmcnt(0)
  s_barrier
  s_barrier
LA_pad:
  s_mov_b32 s60, s28
  s_mov_b32 s61, s29
  s_mov_b32 s62, 7077888
  s_mov_b32 s63, 0x20000
  s_lshr_b32 s3, s2, 3
  s_mul_i32 s3, s3, 54
  s_lshl_b32 s6, s41, 4
  s_add_u32 s3, s3, s6
  v_lshrrev_b32 v150, 3, v1
  v_add_u32 v150, s3, v150
  v_lshlrev_b32 v150, 12, v150
  v_and_b32 v151, 7, v1
  v_lshl_add_u32 v150, v151, 7, v150
  s_bfe_u32 s3, s2, 0x20001
  s_lshl_b32 s3, s3, 10
  buffer_load_dword v151, v150, s[60:63], s3 offen
  v_add_u32 v150, 32768, v150
  buffer_load_dword v152, v150, s[60:63], s3 offen
  s_mov_b32 s60, s20
  s_mov_b32 s61, s21
  s_mov_b32 s62, 819200
  s_mov_b32 s63, 0x20000
  s_lshr_b32 s3, s2, 3
  s_mul_i32 s3, s3, 20
  s_mul_i32 s6, s41, 5
  s_add_u32 s3, s3, s6
  v_lshrrev_b32 v150, 3, v1
  v_min_u32 v150, 4, v150
  v_add_u32 v150, s3, v150
  v_mul_u32_u24 v150, 1280, v150
  v_and_b32 v153, 7, v1
  v_min_u32 v153, 4, v153
  v_lshl_add_u32 v150, v153, 7, v150
  s_and_b32 s3, s2, 1
  s_mul_i32 s3, s3, 640
  buffer_load_dword v153, v150, s[60:63], s3 offen
  v_mov_b32 v28, 0
  v_mov_b32 v29, 0
  v_mov_b32 v30, 0
  v_mov_b32 v31, 0
  s_lshl_b32 s44, s41, 6
  v_add_u32 v2, s44, v1
  v_bfe_u32 v3, v2, 1, 2
  v_lshlrev_b32 v3, 4, v3
  v_lshlrev_b32 v2, 6, v2
  v_xor_b32 v4, 32, v3
  v_add_u32 v4, v4, v2
  v_xor_b32 v3, 48, v3
  v_add_u32 v3, v3, v2
  ds_write_b64 v4, v[28:29] offset:8
  ds_write_b128 v3, v[28:31] offset:0
  ds_write_b64 v4, v[28:29] offset:16392
  ds_write_b128 v3, v[28:31] offset:16384
  ds_write_b64 v4, v[28:29] offset:32776
  ds_write_b128 v3, v[28:31] offset:32768
  ds_write_b64 v4, v[28:29] offset:49160
  ds_write_b128 v3, v[28:31] offset:49152
  s_cmp_ge_u32 s41, 2
  s_cbranch_scc1 Lpz_63
  v_add_u32 v4, 65536, v4
  v_add_u32 v3, 65536, v3
  ds_write_b64 v4, v[28:29] offset:8
  ds_write_b128 v3, v[28:31] offset:0
Lpz_63:
  s_cmp_lg_u32 s41, 3
  s_cbranch_scc1 Lpz_64
  v_lshlrev_b32 v2, 3, v1
  v_add_u32 v2, 110592, v2
  ds_write_b64 v2, v[28:29]
Lpz_64:
  s_waitcnt lgkmcnt(0)
LA_att:
  s_barrier
  v_and_b32 v44, 15, v1
  v_lshrrev_b32 v45, 4, v1
  s_and_b32 s44, s40, 1
  s_mul_i32 s45, s40, 4608
  s_add_u32 s45, s45, 0
  v_bfe_u32 v51, v44, 1, 2
  v_xor_b32 v52, v51, v45
  v_lshlrev_b32 v47, 4, v52
  v_lshl_add_u32 v47, v44, 6, v47
  v_add_u32 v47, s45, v47
  v_add_u32 v46, 512, v47
  v_add_u32 v47, 36864, v47
  v_lshrrev_b32 v52, 2, v44
  v_lshl_add_u32 v52, v45, 2, v52
  v_bfe_u32 v51, v52, 1, 2
  v_bfe_u32 v53, v44, 1, 1
  v_xor_b32 v51, v51, v53
  v_lshlrev_b32 v51, 4, v51
  v_lshl_add_u32 v48, v52, 6, v51
  v_and_b32 v52, 1, v44
  v_lshl_add_u32 v48, v52, 3, v48
  s_add_u32 s46, s45, 73728
  v_add_u32 v48, s46, v48
  v_xor_b32 v55, 32, v48
  s_lshr_b32 s46, s40, 1
  s_mul_i32 s46, s46, 5
  v_lshlrev_b32 v51, 1, v44
  v_add_u32 v51, s44, v51
  v_and_b32 v51, 15, v51
  v_lshrrev_b32 v52, 3, v44
  v_mul_u32_u24 v52, 320, v52
  v_add_u32 v51, v51, v52
  v_add_u32 v52, s46, v45
  v_lshrrev_b32 v53, 2, v52
  v_and_b32 v52, 3, v52
  v_lshlrev_b32 v52, 4, v52
  v_lshl_add_u32 v52, v53, 6, v52
  v_add_u32 v49, v51, v52
  v_lshlrev_b32 v49, 3, v49
  v_add_u32 v49, 142336, v49
  s_add_u32 s46, s46, 4
  v_mov_b32 v52, s46
  v_lshrrev_b32 v53, 2, v52
  v_and_b32 v52, 3, v52
  v_lshlrev_b32 v52, 4, v52
  v_lshl_add_u32 v52, v53, 6, v52
  v_add_u32 v50, v51, v52
  v_lshlrev_b32 v50, 3, v50
  v_add_u32 v50, 142336, v50
  v_lshlrev_b32 v51, 2, v45
  v_sub_u32 v51, v51, v44
  v_mov_b32 v144, 0
  v_mov_b32 v145, 0
  v_mov_b32 v146, 0
  v_mov_b32 v147, 0
  v_mov_b32 v54, 0xffff
  v_mov_b32 v53, 0xffff0000
  v_add_u32 v52, 15, v51
  v_cmp_gt_u32 s[76:77], 8, v52
  v_add_u32 v52, -1, v51
  v_cmp_gt_u32 vcc, 8, v52
  s_nop 1
  v_cndmask_b32 v52, 0, v54, vcc
  v_or_b32 v144, v144, v52
  s_or_b64 s[84:85], vcc, s[76:77]
  v_cndmask_b32 v52, 0, v54, s[76:77]
  v_or_b32 v146, v146, v52
  v_add_u32 v52, 16, v51
  v_cmp_gt_u32 s[78:79], 8, v52
  v_add_u32 v52, 0, v51
  v_cmp_gt_u32 vcc, 8, v52
  s_nop 1
  v_cndmask_b32 v52, 0, v53, vcc
  v_or_b32 v144, v144, v52
  s_or_b64 s[86:87], vcc, s[78:79]
  v_cndmask_b32 v52, 0, v53, s[78:79]
  v_or_b32 v146, v146, v52
  v_add_u32 v52, 17, v51
  v_cmp_gt_u32 s[80:81], 8, v52
  v_add_u32 v52, 1, v51
  v_cmp_gt_u32 vcc, 8, v52
  s_nop 1
  v_cndmask_b32 v52, 0, v54, vcc
  v_or_b32 v145, v145, v52
  s_or_b64 s[88:89], vcc, s[80:81]
  v_cndmask_b32 v52, 0, v54, s[80:81]
  v_or_b32 v147, v147, v52
  v_add_u32 v52, 18, v51
  v_cmp_gt_u32 s[82:83], 8, v52
  v_add_u32 v52, 2, v51
  v_cmp_gt_u32 vcc, 8, v52
  s_nop 1
  v_cndmask_b32 v52, 0, v53, vcc
  v_or_b32 v145, v145, v52
  s_or_b64 s[90:91], vcc, s[82:83]
  v_cndmask_b32 v52, 0, v53, s[82:83]
  v_or_b32 v147, v147, v52
  s_cmp_eq_u32 s43, 0
  s_cselect_b32 s44, 0, -1
  s_and_b32 s92, s84, s44
  s_or_b32 s92, s92, s76
  s_mov_b32 s93, s85
  s_and_b32 s94, s86, s44
  s_or_b32 s94, s94, s78
  s_mov_b32 s95, s87
  s_and_b32 s96, s88, s44
  s_or_b32 s96, s96, s80
  s_mov_b32 s97, s89
  s_and_b32 s98, s90, s44
  s_or_b32 s98, s98, s82
  s_mov_b32 s99, s91
  v_mov_b32 v53, 0xff800000
  s_mov_b32 s45, 0x3ea52b5c
  s_mov_b32 s47, 2
Latt_65:
  ds_read_b128 v[56:59], v46 offset:0
  ds_read_b128 v[100:103], v46 offset:1024
  ds_read_b128 v[60:63], v47 offset:0
  ds_read_b128 v[104:107], v47 offset:1024
  ds_read_b128 v[64:67], v47 offset:1024
  ds_read_b128 v[108:111], v47 offset:2048
  ds_read_b64_tr_b16 v[68:69], v48 offset:0
  ds_read_b64_tr_b16 v[112:113], v48 offset:1024
  ds_read_b64_tr_b16 v[70:71], v48 offset:1024
  ds_read_b64_tr_b16 v[114:115], v48 offset:2048
  ds_read_b64_tr_b16 v[72:73], v55 offset:0
  ds_read_b64_tr_b16 v[116:117], v55 offset:1024
  ds_read_b64_tr_b16 v[74:75], v55 offset:1024
  ds_read_b64_tr_b16 v[118:119], v55 offset:2048
  s_waitcnt lgkmcnt(0)
  v_mfma_f32_16x16x32_bf16 v[76:79], v[60:63], v[56:59], 0
  v_mfma_f32_16x16x32_bf16 v[120:123], v[104:107], v[100:103], 0
  v_mfma_f32_16x16x32_bf16 v[80:83], v[64:67], v[56:59], 0
  v_mfma_f32_16x16x32_bf16 v[124:127], v[108:111], v[100:103], 0
  v_add_u32 v46, 2048, v46
  v_add_u32 v47, 2048, v47
  v_add_u32 v48, 2048, v48
  v_add_u32 v55, 2048, v55
  s_nop 2
  v_cndmask_b32 v76, v76, v80, s[76:77]
  v_cndmask_b32 v120, v120, v124, s[76:77]
  v_cndmask_b32 v77, v77, v81, s[78:79]
  v_cndmask_b32 v121, v121, v125, s[78:79]
  v_cndmask_b32 v78, v78, v82, s[80:81]
  v_cndmask_b32 v122, v122, v126, s[80:81]
  v_cndmask_b32 v79, v79, v83, s[82:83]
  v_cndmask_b32 v123, v123, v127, s[82:83]
  v_cndmask_b32 v76, v53, v76, s[92:93]
  v_cndmask_b32 v120, v53, v120, s[84:85]
  v_cndmask_b32 v77, v53, v77, s[94:95]
  v_cndmask_b32 v121, v53, v121, s[86:87]
  v_cndmask_b32 v78, v53, v78, s[96:97]
  v_cndmask_b32 v122, v53, v122, s[88:89]
  v_cndmask_b32 v79, v53, v79, s[98:99]
  v_cndmask_b32 v123, v53, v123, s[90:91]
  v_max3_f32 v96, v76, v77, v78
  v_max3_f32 v140, v120, v121, v122
  v_max_f32 v96, v96, v79
  v_max_f32 v140, v140, v123
  v_mov_b32 v97, v96
  v_mov_b32 v141, v140
  s_nop 0
  v_permlane16_swap_b32 v96, v97
  v_permlane16_swap_b32 v140, v141
  v_max_f32 v96, v96, v97
  v_max_f32 v140, v140, v141
  v_mov_b32 v97, v96
  v_mov_b32 v141, v140
  s_nop 0
  v_permlane32_swap_b32 v96, v97
  v_permlane32_swap_b32 v140, v141
  v_max_f32 v96, v96, v97
  v_max_f32 v140, v140, v141
  v_mul_f32 v96, s45, v96
  v_mul_f32 v140, s45, v140
  v_fma_f32 v76, v76, s45, -v96
  v_fma_f32 v120, v120, s45, -v140
  v_fma_f32 v77, v77, s45, -v96
  v_fma_f32 v121, v121, s45, -v140
  v_fma_f32 v78, v78, s45, -v96
  v_fma_f32 v122, v122, s45, -v140
  v_fma_f32 v79, v79, s45, -v96
  v_fma_f32 v123, v123, s45, -v140
  v_exp_f32 v76, v76
  v_exp_f32 v120, v120
  v_exp_f32 v77, v77
  v_exp_f32 v121, v121
  v_exp_f32 v78, v78
  v_exp_f32 v122, v122
  v_exp_f32 v79, v79
  v_exp_f32 v123, v123
  v_pk_add_f32 v[80:81], v[76:77], v[78:79]
  v_pk_add_f32 v[124:125], v[120:121], v[122:123]
  v_add_f32 v96, v80, v81
  v_add_f32 v140, v124, v125
  v_mov_b32 v97, v96
  v_mov_b32 v141, v140
  s_nop 0
  v_permlane16_swap_b32 v96, v97
  v_permlane16_swap_b32 v140, v141
  v_add_f32 v96, v96, v97
  v_add_f32 v140, v140, v141
  v_mov_b32 v97, v96
  v_mov_b32 v141, v140
  s_nop 0
  v_permlane32_swap_b32 v96, v97
  v_permlane32_swap_b32 v140, v141
  v_add_f32 v96, v96, v97
  v_add_f32 v140, v140, v141
  v_rcp_f32 v96, v96
  v_rcp_f32 v140, v140
  v_pk_mul_f32 v[76:77], v[76:77], v[96:97] op_sel_hi:[1,0]
  v_pk_mul_f32 v[120:121], v[120:121], v[140:141] op_sel_hi:[1,0]
  v_pk_mul_f32 v[78:79], v[78:79], v[96:97] op_sel_hi:[1,0]
  v_pk_mul_f32 v[122:123], v[122:123], v[140:141] op_sel_hi:[1,0]
  v_cvt_pk_bf16_f32 v80, v76, v77
  v_cvt_pk_bf16_f32 v124, v120, v121
  v_cvt_pk_bf16_f32 v81, v78, v79
  v_cvt_pk_bf16_f32 v125, v122, v123
  v_and_b32 v84, v80, v144
  v_and_b32 v128, v124, v144
  v_and_b32 v85, v81, v145
  v_and_b32 v129, v125, v145
  v_and_b32 v86, v80, v146
  v_and_b32 v130, v124, v146
  v_and_b32 v87, v81, v147
  v_and_b32 v131, v125, v147
  s_nop 0
  v_mfma_f32_16x16x32_bf16 v[88:91], v[68:71], v[84:87], 0
  v_mfma_f32_16x16x32_bf16 v[132:135], v[112:115], v[128:131], 0
  v_mfma_f32_16x16x32_bf16 v[92:95], v[72:75], v[84:87], 0
  v_mfma_f32_16x16x32_bf16 v[136:139], v[116:119], v[128:131], 0
  s_mov_b64 s[92:93], s[84:85]
  s_mov_b64 s[94:95], s[86:87]
  s_mov_b64 s[96:97], s[88:89]
  s_mov_b64 s[98:99], s[90:91]
  s_sub_u32 s47, s47, 1
  v_cvt_pk_bf16_f32 v84, v88, v89
  v_cvt_pk_bf16_f32 v128, v132, v133
  v_cvt_pk_bf16_f32 v85, v90, v91
  v_cvt_pk_bf16_f32 v129, v134, v135
  v_cvt_pk_bf16_f32 v86, v92, v93
  v_cvt_pk_bf16_f32 v130, v136, v137
  v_cvt_pk_bf16_f32 v87, v94, v95
  v_cvt_pk_bf16_f32 v131, v138, v139
  ds_write_b64 v49, v[84:85] offset:0
  ds_write_b64 v49, v[128:129] offset:5120
  s_mov_b64 exec, 0xffff
  ds_write_b64 v50, v[86:87] offset:0
  ds_write_b64 v50, v[130:131] offset:5120
  s_mov_b64 exec, -1
  v_add_u32 v49, 10240, v49
  v_add_u32 v50, 10240, v50
  s_cmp_lg_u32 s47, 0
  s_cbranch_scc1 Latt_65
  s_waitcnt lgkmcnt(0)
  s_barrier
  s_cmp_ge_u32 s40, 4
  s_cbranch_scc1 LA_l_p4
  s_add_u32 s72, s36, 4845568
  s_addc_u32 s73, s37, 0
  s_mov_b32 s74, 2621440
  s_mov_b32 s75, 0x20000
  s_lshl_b32 s44, s43, 3
  s_mul_i32 s44, s44, 20480
  s_mul_i32 s45, s42, 2560
  s_add_u32 s44, s44, s45
  v_and_b32 v44, 0xff, v0
  v_lshlrev_b32 v46, 4, v44
  v_add_u32 v46, 142336, v46
  ds_read_b128 v[56:59], v46 offset:0
  ds_read_b128 v[60:63], v46 offset:4096
  ds_read_b128 v[64:67], v46 offset:8192
  ds_read_b128 v[68:71], v46 offset:12288
  ds_read_b128 v[72:75], v46 offset:16384
  v_add_u32 v46, 0, v44
  v_mul_u32_u24 v45, 3277, v46
  v_lshrrev_b32 v45, 19, v45
  v_mul_u32_u24 v47, 160, v45
  v_sub_u32 v46, v46, v47
  v_mul_u32_u24 v45, 20480, v45
  v_lshl_add_u32 v48, v46, 4, v45
  v_add_u32 v46, 256, v44
  v_mul_u32_u24 v45, 3277, v46
  v_lshrrev_b32 v45, 19, v45
  v_mul_u32_u24 v47, 160, v45
  v_sub_u32 v46, v46, v47
  v_mul_u32_u24 v45, 20480, v45
  v_lshl_add_u32 v49, v46, 4, v45
  v_add_u32 v46, 512, v44
  v_mul_u32_u24 v45, 3277, v46
  v_lshrrev_b32 v45, 19, v45
  v_mul_u32_u24 v47, 160, v45
  v_sub_u32 v46, v46, v47
  v_mul_u32_u24 v45, 20480, v45
  v_lshl_add_u32 v50, v46, 4, v45
  v_add_u32 v46, 768, v44
  v_mul_u32_u24 v45, 3277, v46
  v_lshrrev_b32 v45, 19, v45
  v_mul_u32_u24 v47, 160, v45
  v_sub_u32 v46, v46, v47
  v_mul_u32_u24 v45, 20480, v45
  v_lshl_add_u32 v51, v46, 4, v45
  v_add_u32 v46, 1024, v44
  v_mul_u32_u24 v45, 3277, v46
  v_lshrrev_b32 v45, 19, v45
  v_mul_u32_u24 v47, 160, v45
  v_sub_u32 v46, v46, v47
  v_mul_u32_u24 v45, 20480, v45
  v_lshl_add_u32 v52, v46, 4, v45
  s_waitcnt lgkmcnt(4)
  buffer_store_dwordx4 v[56:59], v48, s[72:75], s44 offen sc1
  s_waitcnt lgkmcnt(3)
  buffer_store_dwordx4 v[60:63], v49, s[72:75], s44 offen sc1
  s_waitcnt lgkmcnt(2)
  buffer_store_dwordx4 v[64:67], v50, s[72:75], s44 offen sc1
  s_waitcnt lgkmcnt(1)
  buffer_store_dwordx4 v[68:71], v51, s[72:75], s44 offen sc1
  s_waitcnt lgkmcnt(0)
  buffer_store_dwordx4 v[72:75], v52, s[72:75], s44 offen sc1
  s_lshl_b32 s4, s43, 7
  s_and_b32 s44, s2, 7
  s_lshr_b32 s45, s2, 3
  s_and_b32 s42, s44, 1
  s_lshl_b32 s42, s42, 2
  s_and_b32 s46, s45, 3
  s_add_u32 s42, s42, s46
  s_lshr_b32 s43, s44, 1
  s_lshl_b32 s43, s43, 3
  s_lshr_b32 s45, s45, 2
  s_add_u32 s43, s43, s45
  s_mul_i32 s44, s46, 0
  s_add_u32 s44, s44, s45
  s_cmp_ge_u32 s44, 10
  s_cselect_b32 s56, 10, 0
  s_sub_u32 s56, s44, s56
  s_mul_i32 s46, s46, 7
  s_mul_i32 s45, s45, 0
  s_add_u32 s45, s45, s46
  s_mul_i32 s44, s45, 2428
  s_lshr_b32 s44, s44, 16
  s_mul_i32 s44, s44, 27
  s_sub_u32 s38, s45, s44
  s_waitcnt vmcnt(0)
  v_mov_b32 v2, 163588
  v_mov_b32 v3, 1
  s_mov_b64 exec, 1
  ds_add_rtn_u32 v3, v2, v3
  s_waitcnt lgkmcnt(0)
  v_readfirstlane_b32 s3, v3
  s_mov_b64 exec, -1
  s_cmp_lg_u32 s3, 3
  s_cbranch_scc1 Lpub_66
  s_mov_b64 exec, 1
  v_mov_b32 v2, s4
  v_mov_b32 v3, 1
  buffer_atomic_add v3, v2, s[12:15], 0 offen sc1
  s_mov_b64 exec, -1
Lpub_66:
  s_mov_b32 s76, s32
  s_mov_b32 s77, s33
  s_mov_b32 s78, 2621440
  s_mov_b32 s79, 0x20000
  s_mov_b32 s80, s16
  s_mov_b32 s81, s17
  s_mov_b32 s82, 2621440
  s_mov_b32 s83, 0x20000
  s_mov_b32 s84, s30
  s_mov_b32 s85, s31
  s_mov_b32 s86, 4096
  s_mov_b32 s87, 0x20000
  s_lshr_b32 s45, s40, 1
  s_and_b32 s44, s40, 1
  s_lshl_b32 s44, s44, 1
  s_add_u32 s55, s44, s45
  s_lshl_b32 s44, s45, 10
  s_add_u32 s44, s44, 10240
  v_lshl_add_u32 v2, v1, 3, s44
  s_lshl_b32 s44, s55, 11
  v_add_u32 v156, s44, v2
  s_xor_b32 s44, s55, 1
  s_lshl_b32 s44, s44, 11
  v_add_u32 v157, s44, v2
  s_lshl_b32 s44, s45, 10
  s_add_u32 s44, s44, 73728
  v_lshl_add_u32 v152, v1, 4, s44
  v_and_b32 v2, 15, v1
  v_lshrrev_b32 v3, 4, v1
  v_lshrrev_b32 v4, 2, v2
  v_lshl_add_u32 v3, v3, 2, v4
  v_and_b32 v2, 3, v2
  v_mul_u32_u24 v155, 160, v3
  v_lshl_add_u32 v155, v2, 3, v155
  s_mul_i32 s44, s45, 5120
  v_add_u32 v155, s44, v155
  v_bfe_u32 v153, v3, 1, 2
  v_xor_b32 v153, s55, v153
  v_lshlrev_b32 v153, 5, v153
  v_lshl_add_u32 v153, v3, 7, v153
  v_lshl_add_u32 v153, v2, 3, v153
  v_xor_b32 v154, 32, v153
  s_lshl_b32 s44, s45, 12
  s_add_u32 s44, s44, 83968
  v_add_u32 v153, s44, v153
  v_add_u32 v154, s44, v154
  s_mul_i32 s44, s40, 5120
  s_add_u32 s44, s44, 0
  v_lshl_add_u32 v174, v1, 4, s44
  s_xor_b32 s44, s40, 2
  s_mul_i32 s44, s44, 5120
  s_add_u32 s44, s44, 0
  v_lshl_add_u32 v175, v1, 4, s44
  s_lshl_b32 s44, s43, 2
  s_add_u32 s44, s44, s55
  s_lshl_b32 s44, s44, 4
  v_and_b32 v2, 15, v1
  v_add_u32 v2, s44, v2
  v_lshlrev_b32 v3, 1, v2
  buffer_load_ushort v158, v3, s[84:87], 0 offen
  v_mul_u32_u24 v2, 1280, v2
  v_lshrrev_b32 v3, 4, v1
  v_lshl_add_u32 v160, v3, 3, v2
  s_mul_i32 s59, s42, 160
  buffer_load_dwordx2 v[162:163], v160, s[80:83], s59 offen offset:0
  buffer_load_dwordx2 v[164:165], v160, s[80:83], s59 offen offset:32
  buffer_load_dwordx2 v[166:167], v160, s[80:83], s59 offen offset:64
  buffer_load_dwordx2 v[168:169], v160, s[80:83], s59 offen offset:96
  buffer_load_dwordx2 v[170:171], v160, s[80:83], s59 offen offset:128
  s_waitcnt vmcnt(0)
  s_branch L_c_p4b
LA_l_p4:
L_l_p4_nok:
  s_mov_b32 s7, 0
  s_cmp_ge_u32 s41, 2
  s_cbranch_scc1 L_p4ldB
  s_and_b32 s44, s2, 7
  s_lshr_b32 s45, s2, 3
  s_and_b32 s42, s44, 1
  s_lshl_b32 s42, s42, 2
  s_and_b32 s46, s45, 3
  s_add_u32 s42, s42, s46
  s_lshr_b32 s43, s44, 1
  s_lshl_b32 s43, s43, 3
  s_lshr_b32 s45, s45, 2
  s_add_u32 s43, s43, s45
  s_mul_i32 s44, s46, 0
  s_add_u32 s44, s44, s45
  s_cmp_ge_u32 s44, 10
  s_cselect_b32 s56, 10, 0
  s_sub_u32 s56, s44, s56
  s_mul_i32 s46, s46, 7
  s_mul_i32 s45, s45, 0
  s_add_u32 s45, s45, s46
  s_mul_i32 s44, s45, 2428
  s_lshr_b32 s44, s44, 16
  s_mul_i32 s44, s44, 27
  s_sub_u32 s38, s45, s44
  s_add_u32 s60, s36, 2629632
  s_addc_u32 s61, s37, 0
  s_mov_b32 s62, 2211840
  s_mov_b32 s63, 0x20000
  s_add_u32 s68, s36, 4845568
  s_addc_u32 s69, s37, 0
  s_mov_b32 s70, 2621440
  s_mov_b32 s71, 0x20000
  s_mov_b32 s64, s20
  s_mov_b32 s65, s21
  s_mov_b32 s66, 819200
  s_mov_b32 s67, 0x20000
  s_mov_b32 s72, s28
  s_mov_b32 s73, s29
  s_mov_b32 s74, 7077888
  s_mov_b32 s75, 0x20000
  s_lshr_b32 s4, s43, 1
  s_lshl_b32 s4, s4, 7
  s_lshl_b32 s5, s42, 7
  s_add_u32 s5, s5, 2048
  s_lshl_b32 s46, s43, 2
  s_mul_i32 s46, s46, 20480
  v_lshl_add_u32 v2, v1, 4, s46
  s_add_u32 s44, s41, 0
  s_lshl_b32 s44, s44, 6
  v_add_u32 v3, s44, v1
  v_mul_u32_u24 v4, 6554, v3
  v_lshrrev_b32 v4, 16, v4
  v_mul_u32_u24 v26, 10, v4
  v_sub_u32 v3, v3, v26
  v_mul_u32_u24 v4, 1280, v4
  v_lshl_add_u32 v26, v3, 4, v4
  s_mul_i32 s44, s42, 160
  v_add_u32 v26, s44, v26
  s_add_u32 s44, s41, 4
  s_lshl_b32 s44, s44, 6
  v_add_u32 v3, s44, v1
  v_mul_u32_u24 v4, 6554, v3
  v_lshrrev_b32 v4, 16, v4
  v_mul_u32_u24 v27, 10, v4
  v_sub_u32 v3, v3, v27
  v_mul_u32_u24 v4, 1280, v4
  v_lshl_add_u32 v27, v3, 4, v4
  s_mul_i32 s44, s42, 160
  v_add_u32 v27, s44, v27
  s_add_u32 s44, s41, 8
  s_lshl_b32 s44, s44, 6
  v_add_u32 v3, s44, v1
  v_mul_u32_u24 v4, 6554, v3
  v_lshrrev_b32 v4, 16, v4
  v_mul_u32_u24 v28, 10, v4
  v_sub_u32 v3, v3, v28
  v_mul_u32_u24 v4, 1280, v4
  v_lshl_add_u32 v28, v3, 4, v4
  s_mul_i32 s44, s42, 160
  v_add_u32 v28, s44, v28
  s_add_i32 s44, s41, 2
  s_lshr_b32 s45, s44, 1
  s_mul_i32 s45, s45, 20480
  s_and_b32 s44, s44, 1
  s_lshl_b32 s44, s44, 10
  s_add_u32 s44, s44, s45
  v_add_u32 v29, s44, v2
  s_add_i32 s44, s41, 6
  s_lshr_b32 s45, s44, 1
  s_mul_i32 s45, s45, 20480
  s_and_b32 s44, s44, 1
  s_lshl_b32 s44, s44, 10
  s_add_u32 s44, s44, s45
  v_add_u32 v30, s44, v2
  s_mul_i32 s46, s42, 276480
  s_lshr_b32 s44, s41, 1
  s_mul_i32 s44, s44, 55296
  s_add_u32 s46, s46, s44
  s_and_b32 s44, s41, 1
  s_lshl_b32 s44, s44, 10
  s_add_u32 s46, s46, s44
  v_lshl_add_u32 v2, v1, 4, s46
  v_lshrrev_b32 v4, 4, v1
  v_lshlrev_b32 v4, 1, v4
  v_and_b32 v3, 7, v1
  v_xor_b32 v3, v3, v4
  v_lshlrev_b32 v3, 4, v3
  v_lshrrev_b32 v4, 3, v1
  v_lshl_add_u32 v3, v4, 12, v3
  s_lshl_b32 s44, s43, 7
  v_add_u32 v3, s44, v3
  v_add_u32 v31, 0, v2
  v_add_u32 v32, 110592, v2
  v_add_u32 v33, 221184, v2
  s_add_i32 s44, s41, 2
  s_lshl_b32 s44, s44, 15
  v_add_u32 v34, s44, v3
  s_add_i32 s44, s41, 6
  s_lshl_b32 s44, s44, 15
  v_add_u32 v35, s44, v3
  s_lshl_b32 s51, s41, 10
  s_mov_b32 s52, s51
  s_add_u32 s53, s51, 110592
  s_mul_i32 s49, s56, 2048
  s_mul_i32 s50, s56, 81920
  s_mul_i32 s57, s38, 2048
  s_mul_i32 s58, s38, 262144
L_l_p4_v0:
  s_mov_b32 s51, s52
  s_mov_b32 s47, 5
Lpp_67:
  s_add_u32 m0, s51, 0
  s_nop 0
  buffer_load_dwordx4 v26, s[64:67], s50 offen  lds
  s_add_u32 m0, s51, 4096
  s_nop 0
  buffer_load_dwordx4 v27, s[64:67], s50 offen  lds
  s_add_u32 m0, s51, 8192
  s_nop 0
  buffer_load_dwordx4 v28, s[64:67], s50 offen  lds
  s_add_u32 s50, s50, 81920
  s_cmp_eq_u32 s50, 819200
  s_cselect_b32 s50, 0, s50
  s_add_u32 s51, s51, 18432
  s_cmp_eq_u32 s51, s53
  s_cselect_b32 s51, s52, s51
  s_sub_u32 s47, s47, 1
  s_cmp_lg_u32 s47, 0
  s_cbranch_scc1 Lpp_67
  s_cmp_lg_u32 s41, 0
  s_cbranch_scc1 Lso_68
  s_cmp_eq_u32 s7, 0
  s_cbranch_scc1 Lsblk_71
  v_readfirstlane_b32 s3, v37
  s_nop 0
  s_cmp_ge_u32 s3, 8
  s_cbranch_scc1 Lsok_70
Lsblk_71:
  s_mov_b32 s3, 262144
  v_mov_b32 v2, 0
  v_mov_b32 v3, 0
  s_mov_b32 vcc_lo, 224
  v_writelane_b32 v2, vcc_lo, 0
  s_mov_b32 vcc_lo, 1
  v_writelane_b32 v3, vcc_lo, 0
  v_writelane_b32 v2, s4, 1
  s_mov_b32 vcc_lo, 8
  v_writelane_b32 v3, vcc_lo, 1
LpollO_72:
  s_mov_b64 exec, 1
  buffer_load_dword v4, v2, s[8:11], 0 offen sc1
  s_mov_b64 exec, 2
  buffer_load_dword v4, v2, s[12:15], 0 offen sc1
  s_mov_b64 exec, 3
  s_waitcnt vmcnt(0)
  v_cmp_lt_u32 vcc, v4, v3
  s_nop 3
  s_cmp_eq_u64 vcc, 0
  s_cbranch_scc1 LpolldO_73
  s_sleep 4
  s_sub_u32 s3, s3, 1
  s_cmp_lg_u32 s3, 0
  s_cbranch_scc1 LpollO_72
LpolldO_73:
  s_mov_b64 exec, -1
Lsok_70:
  v_mov_b32 v2, 163596
  v_mov_b32 v3, 1
  s_mov_b64 exec, 1
  ds_write_b32 v2, v3
  s_mov_b64 exec, -1
  s_branch Lsod_69
Lso_68:
  v_mov_b32 v2, 163596
Lfw_74:
  ds_read_b32 v3, v2
  s_waitcnt lgkmcnt(0)
  v_readfirstlane_b32 s3, v3
  s_nop 0
  s_cmp_lg_u32 s3, 0
  s_cbranch_scc1 Lfd_75
  s_sleep 1
  s_branch Lfw_74
Lfd_75:
Lsod_69:
  s_mov_b32 s51, s52
  s_mov_b32 s47, 5
Lpp_76:
  s_add_u32 m0, s51, 12288
  s_nop 0
  buffer_load_dwordx4 v29, s[68:71], s49 offen sc1 lds
  s_add_u32 m0, s51, 16384
  s_nop 0
  buffer_load_dwordx4 v30, s[68:71], s49 offen sc1 lds
  s_add_u32 s49, s49, 2048
  s_cmp_eq_u32 s49, 20480
  s_cselect_b32 s49, 0, s49
  s_add_u32 s51, s51, 18432
  s_cmp_eq_u32 s51, s53
  s_cselect_b32 s51, s52, s51
  s_sub_u32 s47, s47, 1
  s_cmp_lg_u32 s47, 0
  s_cbranch_scc1 Lpp_76
  s_mov_b32 m0, s51
  s_mov_b32 s47, 5
L4e_77:
  s_cmp_lg_u32 s47, 5
  s_cbranch_scc1 L4nx_79
  s_waitcnt vmcnt(8)
  s_branch L4go_78
L4nx_79:
  s_cmp_lg_u32 s47, 4
  s_cbranch_scc1 L4nx_80
  s_waitcnt vmcnt(11)
  s_branch L4go_78
L4nx_80:
  s_cmp_lg_u32 s47, 3
  s_cbranch_scc1 L4nx_81
  s_waitcnt vmcnt(14)
  s_cmp_lg_u32 s41, 0
  s_cbranch_scc1 Lpi_82
  v_mov_b32 v36, s5
  buffer_load_dword v37, v36, s[12:15], 0 offen sc1
Lpi_82:
  s_branch L4go_78
L4nx_81:
  s_cmp_lg_u32 s47, 2
  s_cbranch_scc1 L4nx_83
  s_waitcnt vmcnt(17)
  s_branch L4go_78
L4nx_83:
  s_waitcnt vmcnt(20)
L4go_78:
  s_barrier
  buffer_load_dwordx4 v26, s[64:67], s50 offen  lds
  s_add_u32 m0, s51, 4096
  s_add_u32 s46, s49, 2048
  s_cmp_eq_u32 s46, 20480
  s_cselect_b32 s46, 0, s46
  buffer_load_dwordx4 v27, s[64:67], s50 offen  lds
  s_add_u32 m0, s51, 8192
  s_nop 0
  buffer_load_dwordx4 v28, s[64:67], s50 offen  lds
  s_add_u32 m0, s51, 12288
  s_add_u32 s50, s50, 81920
  s_cmp_eq_u32 s50, 819200
  s_cselect_b32 s50, 0, s50
  buffer_load_dwordx4 v29, s[68:71], s49 offen sc1 lds
  s_add_u32 m0, s51, 16384
  s_add_u32 s51, s51, 18432
  s_cmp_eq_u32 s51, s53
  s_cselect_b32 s51, s52, s51
  s_sub_u32 s47, s47, 1
  s_cmp_lg_u32 s47, 0
  buffer_load_dwordx4 v30, s[68:71], s49 offen sc1 lds
  s_mov_b32 s49, s46
  s_mov_b32 m0, s51
  s_cbranch_scc1 L4e_77
  s_cmp_lg_u32 s41, 0
  s_cbranch_scc1 Lpf_85
  s_waitcnt vmcnt(15)
  v_readfirstlane_b32 s3, v37
  s_nop 0
  s_cmp_ge_u32 s3, 14
  s_cbranch_scc1 Lpfo_87
  s_mov_b32 s3, 262144
  v_mov_b32 v2, 0
  v_mov_b32 v3, 0
  v_writelane_b32 v2, s5, 0
  s_mov_b32 vcc_lo, 14
  v_writelane_b32 v3, vcc_lo, 0
LpollU_88:
  s_mov_b64 exec, 1
  buffer_load_dword v4, v2, s[12:15], 0 offen sc1
  s_mov_b64 exec, 1
  s_waitcnt vmcnt(0)
  v_cmp_lt_u32 vcc, v4, v3
  s_nop 3
  s_cmp_eq_u64 vcc, 0
  s_cbranch_scc1 LpolldU_89
  s_sleep 4
  s_sub_u32 s3, s3, 1
  s_cmp_lg_u32 s3, 0
  s_cbranch_scc1 LpollU_88
LpolldU_89:
  s_mov_b64 exec, -1
Lpfo_87:
  v_mov_b32 v2, 163600
  v_mov_b32 v3, 1
  s_mov_b64 exec, 1
  ds_write_b32 v2, v3
  s_mov_b64 exec, -1
  s_branch Lpfd_86
Lpf_85:
  v_mov_b32 v2, 163600
Lfw_90:
  ds_read_b32 v3, v2
  s_waitcnt lgkmcnt(0)
  v_readfirstlane_b32 s3, v3
  s_nop 0
  s_cmp_lg_u32 s3, 0
  s_cbranch_scc1 Lfd_91
  s_sleep 1
  s_branch Lfw_90
Lfd_91:
Lpfd_86:
  s_mov_b32 m0, s51
  s_mov_b32 s47, 27
  s_waitcnt vmcnt(20)
  s_barrier
  buffer_load_dwordx4 v31, s[60:63], s57 offen sc1 lds
  s_add_u32 m0, s51, 4096
  s_add_u32 s46, s58, 262144
  s_cmp_eq_u32 s46, 7077888
  s_cselect_b32 s46, 0, s46
Lld_92:
  buffer_load_dwordx4 v32, s[60:63], s57 offen sc1 lds
  s_add_u32 m0, s51, 8192
  s_nop 0
  buffer_load_dwordx4 v33, s[60:63], s57 offen sc1 lds
  s_add_u32 m0, s51, 12288
  s_add_u32 s57, s57, 2048
  s_cmp_eq_u32 s57, 55296
  s_cselect_b32 s57, 0, s57
  buffer_load_dwordx4 v34, s[72:75], s58 offen  lds
  s_add_u32 m0, s51, 16384
  s_add_u32 s51, s51, 18432
  s_cmp_eq_u32 s51, s53
  s_cselect_b32 s51, s52, s51
  s_sub_u32 s47, s47, 1
  s_cmp_lg_u32 s47, 0
  buffer_load_dwordx4 v35, s[72:75], s58 offen  lds
  s_mov_b32 s58, s46
  s_mov_b32 m0, s51
  s_cbranch_scc0 Lldx_93
  s_waitcnt vmcnt(20)
  s_barrier
  buffer_load_dwordx4 v31, s[60:63], s57 offen sc1 lds
  s_add_u32 m0, s51, 4096
  s_add_u32 s46, s58, 262144
  s_cmp_eq_u32 s46, 7077888
  s_cselect_b32 s46, 0, s46
  s_branch Lld_92
Lldx_93:
  s_waitcnt vmcnt(20)
  s_barrier
  s_waitcnt vmcnt(15)
  s_barrier
  s_waitcnt vmcnt(10)
  s_barrier
  s_waitcnt vmcnt(5)
  s_barrier
  s_waitcnt vmcnt(0)
  s_barrier
  s_barrier
  s_barrier
  s_endpgm
L_p4ldB:
  s_and_b32 s44, s2, 7
  s_lshr_b32 s45, s2, 3
  s_and_b32 s42, s44, 1
  s_lshl_b32 s42, s42, 2
  s_and_b32 s46, s45, 3
  s_add_u32 s42, s42, s46
  s_lshr_b32 s43, s44, 1
  s_lshl_b32 s43, s43, 3
  s_lshr_b32 s45, s45, 2
  s_add_u32 s43, s43, s45
  s_mul_i32 s44, s46, 0
  s_add_u32 s44, s44, s45
  s_cmp_ge_u32 s44, 10
  s_cselect_b32 s56, 10, 0
  s_sub_u32 s56, s44, s56
  s_mul_i32 s46, s46, 7
  s_mul_i32 s45, s45, 0
  s_add_u32 s45, s45, s46
  s_mul_i32 s44, s45, 2428
  s_lshr_b32 s44, s44, 16
  s_mul_i32 s44, s44, 27
  s_sub_u32 s38, s45, s44
  s_add_u32 s60, s36, 2629632
  s_addc_u32 s61, s37, 0
  s_mov_b32 s62, 2211840
  s_mov_b32 s63, 0x20000
  s_add_u32 s68, s36, 4845568
  s_addc_u32 s69, s37, 0
  s_mov_b32 s70, 2621440
  s_mov_b32 s71, 0x20000
  s_mov_b32 s64, s20
  s_mov_b32 s65, s21
  s_mov_b32 s66, 819200
  s_mov_b32 s67, 0x20000
  s_mov_b32 s72, s28
  s_mov_b32 s73, s29
  s_mov_b32 s74, 7077888
  s_mov_b32 s75, 0x20000
  s_lshr_b32 s4, s43, 1
  s_lshl_b32 s4, s4, 7
  s_lshl_b32 s5, s42, 7
  s_add_u32 s5, s5, 2048
  s_lshl_b32 s46, s43, 2
  s_mul_i32 s46, s46, 20480
  v_lshl_add_u32 v2, v1, 4, s46
  s_add_u32 s44, s41, 0
  s_lshl_b32 s44, s44, 6
  v_add_u32 v3, s44, v1
  v_mul_u32_u24 v4, 6554, v3
  v_lshrrev_b32 v4, 16, v4
  v_mul_u32_u24 v26, 10, v4
  v_sub_u32 v3, v3, v26
  v_mul_u32_u24 v4, 1280, v4
  v_lshl_add_u32 v26, v3, 4, v4
  s_mul_i32 s44, s42, 160
  v_add_u32 v26, s44, v26
  s_add_u32 s44, s41, 4
  s_lshl_b32 s44, s44, 6
  v_add_u32 v3, s44, v1
  v_mul_u32_u24 v4, 6554, v3
  v_lshrrev_b32 v4, 16, v4
  v_mul_u32_u24 v27, 10, v4
  v_sub_u32 v3, v3, v27
  v_mul_u32_u24 v4, 1280, v4
  v_lshl_add_u32 v27, v3, 4, v4
  s_mul_i32 s44, s42, 160
  v_add_u32 v27, s44, v27
  s_add_i32 s44, s41, -2
  s_lshr_b32 s45, s44, 1
  s_mul_i32 s45, s45, 20480
  s_and_b32 s44, s44, 1
  s_lshl_b32 s44, s44, 10
  s_add_u32 s44, s44, s45
  v_add_u32 v28, s44, v2
  s_add_i32 s44, s41, 2
  s_lshr_b32 s45, s44, 1
  s_mul_i32 s45, s45, 20480
  s_and_b32 s44, s44, 1
  s_lshl_b32 s44, s44, 10
  s_add_u32 s44, s44, s45
  v_add_u32 v29, s44, v2
  s_mul_i32 s46, s42, 276480
  s_lshr_b32 s44, s41, 1
  s_mul_i32 s44, s44, 55296
  s_add_u32 s46, s46, s44
  s_and_b32 s44, s41, 1
  s_lshl_b32 s44, s44, 10
  s_add_u32 s46, s46, s44
  v_lshl_add_u32 v2, v1, 4, s46
  v_lshrrev_b32 v4, 4, v1
  v_lshlrev_b32 v4, 1, v4
  v_and_b32 v3, 7, v1
  v_xor_b32 v3, v3, v4
  v_lshlrev_b32 v3, 4, v3
  v_lshrrev_b32 v4, 3, v1
  v_lshl_add_u32 v3, v4, 12, v3
  s_lshl_b32 s44, s43, 7
  v_add_u32 v3, s44, v3
  v_add_u32 v31, 0, v2
  v_add_u32 v32, 110592, v2
  s_add_i32 s44, s41, -2
  s_lshl_b32 s44, s44, 15
  v_add_u32 v33, s44, v3
  s_add_i32 s44, s41, 2
  s_lshl_b32 s44, s44, 15
  v_add_u32 v34, s44, v3
  s_lshl_b32 s51, s41, 10
  s_mov_b32 s52, s51
  s_add_u32 s53, s51, 110592
  s_mul_i32 s49, s56, 2048
  s_mul_i32 s50, s56, 81920
  s_mul_i32 s57, s38, 2048
  s_mul_i32 s58, s38, 262144
L_l_p4_v1:
  s_mov_b32 s51, s52
  s_mov_b32 s47, 5
Lpp_94:
  s_add_u32 m0, s51, 0
  s_nop 0
  buffer_load_dwordx4 v26, s[64:67], s50 offen  lds
  s_add_u32 m0, s51, 4096
  s_nop 0
  buffer_load_dwordx4 v27, s[64:67], s50 offen  lds
  s_add_u32 s50, s50, 81920
  s_cmp_eq_u32 s50, 819200
  s_cselect_b32 s50, 0, s50
  s_add_u32 s51, s51, 18432
  s_cmp_eq_u32 s51, s53
  s_cselect_b32 s51, s52, s51
  s_sub_u32 s47, s47, 1
  s_cmp_lg_u32 s47, 0
  s_cbranch_scc1 Lpp_94
  v_mov_b32 v2, 163596
Lfw_95:
  ds_read_b32 v3, v2
  s_waitcnt lgkmcnt(0)
  v_readfirstlane_b32 s3, v3
  s_nop 0
  s_cmp_lg_u32 s3, 0
  s_cbranch_scc1 Lfd_96
  s_sleep 1
  s_branch Lfw_95
Lfd_96:
  s_mov_b32 s51, s52
  s_mov_b32 s47, 5
Lpp_97:
  s_add_u32 m0, s51, 8192
  s_nop 0
  buffer_load_dwordx4 v28, s[68:71], s49 offen sc1 lds
  s_add_u32 m0, s51, 12288
  s_nop 0
  buffer_load_dwordx4 v29, s[68:71], s49 offen sc1 lds
  s_add_u32 s49, s49, 2048
  s_cmp_eq_u32 s49, 20480
  s_cselect_b32 s49, 0, s49
  s_add_u32 s51, s51, 18432
  s_cmp_eq_u32 s51, s53
  s_cselect_b32 s51, s52, s51
  s_sub_u32 s47, s47, 1
  s_cmp_lg_u32 s47, 0
  s_cbranch_scc1 Lpp_97
  s_mov_b32 m0, s51
  s_mov_b32 s47, 5
L4e_98:
  s_cmp_lg_u32 s47, 5
  s_cbranch_scc1 L4nx_100
  s_waitcnt vmcnt(8)
  s_branch L4go_99
L4nx_100:
  s_cmp_lg_u32 s47, 4
  s_cbranch_scc1 L4nx_101
  s_waitcnt vmcnt(10)
  s_branch L4go_99
L4nx_101:
  s_cmp_lg_u32 s47, 3
  s_cbranch_scc1 L4nx_102
  s_waitcnt vmcnt(12)
  s_branch L4go_99
L4nx_102:
  s_cmp_lg_u32 s47, 2
  s_cbranch_scc1 L4nx_103
  s_waitcnt vmcnt(14)
  s_branch L4go_99
L4nx_103:
  s_waitcnt vmcnt(16)
L4go_99:
  s_barrier
  buffer_load_dwordx4 v26, s[64:67], s50 offen  lds
  s_add_u32 m0, s51, 4096
  s_add_u32 s46, s49, 2048
  s_cmp_eq_u32 s46, 20480
  s_cselect_b32 s46, 0, s46
  buffer_load_dwordx4 v27, s[64:67], s50 offen  lds
  s_add_u32 m0, s51, 8192
  s_add_u32 s50, s50, 81920
  s_cmp_eq_u32 s50, 819200
  s_cselect_b32 s50, 0, s50
  buffer_load_dwordx4 v28, s[68:71], s49 offen sc1 lds
  s_add_u32 m0, s51, 12288
  s_add_u32 s51, s51, 18432
  s_cmp_eq_u32 s51, s53
  s_cselect_b32 s51, s52, s51
  s_sub_u32 s47, s47, 1
  s_cmp_lg_u32 s47, 0
  buffer_load_dwordx4 v29, s[68:71], s49 offen sc1 lds
  s_mov_b32 s49, s46
  s_mov_b32 m0, s51
  s_cbranch_scc1 L4e_98
  v_mov_b32 v2, 163600
Lfw_105:
  ds_read_b32 v3, v2
  s_waitcnt lgkmcnt(0)
  v_readfirstlane_b32 s3, v3
  s_nop 0
  s_cmp_lg_u32 s3, 0
  s_cbranch_scc1 Lfd_106
  s_sleep 1
  s_branch Lfw_105
Lfd_106:
  s_mov_b32 m0, s51
  s_mov_b32 s47, 27
  s_waitcnt vmcnt(16)
  s_barrier
  buffer_load_dwordx4 v31, s[60:63], s57 offen sc1 lds
  s_add_u32 m0, s51, 4096
  s_add_u32 s46, s58, 262144
  s_cmp_eq_u32 s46, 7077888
  s_cselect_b32 s46, 0, s46
Lld_107:
  buffer_load_dwordx4 v32, s[60:63], s57 offen sc1 lds
  s_add_u32 m0, s51, 8192
  s_add_u32 s57, s57, 2048
  s_cmp_eq_u32 s57, 55296
  s_cselect_b32 s57, 0, s57
  buffer_load_dwordx4 v33, s[72:75], s58 offen  lds
  s_add_u32 m0, s51, 12288
  s_add_u32 s51, s51, 18432
  s_cmp_eq_u32 s51, s53
  s_cselect_b32 s51, s52, s51
  s_sub_u32 s47, s47, 1
  s_cmp_lg_u32 s47, 0
  buffer_load_dwordx4 v34, s[72:75], s58 offen  lds
  s_mov_b32 s58, s46
  s_mov_b32 m0, s51
  s_cbranch_scc0 Lldx_108
  s_waitcnt vmcnt(16)
  s_barrier
  buffer_load_dwordx4 v31, s[60:63], s57 offen sc1 lds
  s_add_u32 m0, s51, 4096
  s_add_u32 s46, s58, 262144
  s_cmp_eq_u32 s46, 7077888
  s_cselect_b32 s46, 0, s46
  s_branch Lld_107
Lldx_108:
  s_waitcnt vmcnt(16)
  s_barrier
  s_waitcnt vmcnt(12)
  s_barrier
  s_waitcnt vmcnt(8)
  s_barrier
  s_waitcnt vmcnt(4)
  s_barrier
  s_waitcnt vmcnt(0)
  s_barrier
  s_barrier
  s_barrier
  s_endpgm
L_c_p4:
  s_and_b32 s44, s2, 7
  s_lshr_b32 s45, s2, 3
  s_and_b32 s42, s44, 1
  s_lshl_b32 s42, s42, 2
  s_and_b32 s46, s45, 3
  s_add_u32 s42, s42, s46
  s_lshr_b32 s43, s44, 1
  s_lshl_b32 s43, s43, 3
  s_lshr_b32 s45, s45, 2
  s_add_u32 s43, s43, s45
  s_mul_i32 s44, s46, 0
  s_add_u32 s44, s44, s45
  s_cmp_ge_u32 s44, 10
  s_cselect_b32 s56, 10, 0
  s_sub_u32 s56, s44, s56
  s_mul_i32 s46, s46, 7
  s_mul_i32 s45, s45, 0
  s_add_u32 s45, s45, s46
  s_mul_i32 s44, s45, 2428
  s_lshr_b32 s44, s44, 16
  s_mul_i32 s44, s44, 27
  s_sub_u32 s38, s45, s44
  s_mov_b32 s76, s32
  s_mov_b32 s77, s33
  s_mov_b32 s78, 2621440
  s_mov_b32 s79, 0x20000
  s_mov_b32 s80, s16
  s_mov_b32 s81, s17
  s_mov_b32 s82, 2621440
  s_mov_b32 s83, 0x20000
  s_mov_b32 s84, s30
  s_mov_b32 s85, s31
  s_mov_b32 s86, 4096
  s_mov_b32 s87, 0x20000
  s_lshr_b32 s45, s40, 1
  s_and_b32 s44, s40, 1
  s_lshl_b32 s44, s44, 1
  s_add_u32 s55, s44, s45
  s_lshl_b32 s44, s45, 10
  s_add_u32 s44, s44, 10240
  v_lshl_add_u32 v2, v1, 3, s44
  s_lshl_b32 s44, s55, 11
  v_add_u32 v156, s44, v2
  s_xor_b32 s44, s55, 1
  s_lshl_b32 s44, s44, 11
  v_add_u32 v157, s44, v2
  s_lshl_b32 s44, s45, 10
  s_add_u32 s44, s44, 73728
  v_lshl_add_u32 v152, v1, 4, s44
  v_and_b32 v2, 15, v1
  v_lshrrev_b32 v3, 4, v1
  v_lshrrev_b32 v4, 2, v2
  v_lshl_add_u32 v3, v3, 2, v4
  v_and_b32 v2, 3, v2
  v_mul_u32_u24 v155, 160, v3
  v_lshl_add_u32 v155, v2, 3, v155
  s_mul_i32 s44, s45, 5120
  v_add_u32 v155, s44, v155
  v_bfe_u32 v153, v3, 1, 2
  v_xor_b32 v153, s55, v153
  v_lshlrev_b32 v153, 5, v153
  v_lshl_add_u32 v153, v3, 7, v153
  v_lshl_add_u32 v153, v2, 3, v153
  v_xor_b32 v154, 32, v153
  s_lshl_b32 s44, s45, 12
  s_add_u32 s44, s44, 83968
  v_add_u32 v153, s44, v153
  v_add_u32 v154, s44, v154
  s_mul_i32 s44, s40, 5120
  s_add_u32 s44, s44, 0
  v_lshl_add_u32 v174, v1, 4, s44
  s_xor_b32 s44, s40, 2
  s_mul_i32 s44, s44, 5120
  s_add_u32 s44, s44, 0
  v_lshl_add_u32 v175, v1, 4, s44
  s_lshl_b32 s44, s43, 2
  s_add_u32 s44, s44, s55
  s_lshl_b32 s44, s44, 4
  v_and_b32 v2, 15, v1
  v_add_u32 v2, s44, v2
  v_lshlrev_b32 v3, 1, v2
  buffer_load_ushort v158, v3, s[84:87], 0 offen
  v_mul_u32_u24 v2, 1280, v2
  v_lshrrev_b32 v3, 4, v1
  v_lshl_add_u32 v160, v3, 3, v2
  s_mul_i32 s59, s42, 160
  buffer_load_dwordx2 v[162:163], v160, s[80:83], s59 offen offset:0
  buffer_load_dwordx2 v[164:165], v160, s[80:83], s59 offen offset:32
  buffer_load_dwordx2 v[166:167], v160, s[80:83], s59 offen offset:64
  buffer_load_dwordx2 v[168:169], v160, s[80:83], s59 offen offset:96
  buffer_load_dwordx2 v[170:171], v160, s[80:83], s59 offen offset:128
  s_waitcnt vmcnt(0)
L_c_p4b:
  v_lshlrev_b32 v158, 16, v158
  v_mov_b64 v[124:125], 0
  v_mov_b64 v[126:127], 0
  v_lshlrev_b32 v104, 16, v162
  v_and_b32 v105, 0xffff0000, v162
  v_lshlrev_b32 v106, 16, v163
  v_and_b32 v107, 0xffff0000, v163
  v_pk_add_f32 v[104:105], v[104:105], v[158:159] op_sel_hi:[1,0]
  v_pk_add_f32 v[106:107], v[106:107], v[158:159] op_sel_hi:[1,0]
  v_mov_b64 v[128:129], 0
  v_mov_b64 v[130:131], 0
  v_lshlrev_b32 v108, 16, v164
  v_and_b32 v109, 0xffff0000, v164
  v_lshlrev_b32 v110, 16, v165
  v_and_b32 v111, 0xffff0000, v165
  v_pk_add_f32 v[108:109], v[108:109], v[158:159] op_sel_hi:[1,0]
  v_pk_add_f32 v[110:111], v[110:111], v[158:159] op_sel_hi:[1,0]
  v_mov_b64 v[132:133], 0
  v_mov_b64 v[134:135], 0
  v_lshlrev_b32 v112, 16, v166
  v_and_b32 v113, 0xffff0000, v166
  v_lshlrev_b32 v114, 16, v167
  v_and_b32 v115, 0xffff0000, v167
  v_pk_add_f32 v[112:113], v[112:113], v[158:159] op_sel_hi:[1,0]
  v_pk_add_f32 v[114:115], v[114:115], v[158:159] op_sel_hi:[1,0]
  v_mov_b64 v[136:137], 0
  v_mov_b64 v[138:139], 0
  v_lshlrev_b32 v116, 16, v168
  v_and_b32 v117, 0xffff0000, v168
  v_lshlrev_b32 v118, 16, v169
  v_and_b32 v119, 0xffff0000, v169
  v_pk_add_f32 v[116:117], v[116:117], v[158:159] op_sel_hi:[1,0]
  v_pk_add_f32 v[118:119], v[118:119], v[158:159] op_sel_hi:[1,0]
  v_mov_b64 v[140:141], 0
  v_mov_b64 v[142:143], 0
  v_lshlrev_b32 v120, 16, v170
  v_and_b32 v121, 0xffff0000, v170
  v_lshlrev_b32 v122, 16, v171
  v_and_b32 v123, 0xffff0000, v171
  v_pk_add_f32 v[120:121], v[120:121], v[158:159] op_sel_hi:[1,0]
  v_pk_add_f32 v[122:123], v[122:123], v[158:159] op_sel_hi:[1,0]
  s_mov_b32 s48, 0
  s_mov_b32 s47, 5
  s_barrier
  ds_read_b64_tr_b16 a[0:1], v155 offset:0
  ds_read_b64_tr_b16 a[2:3], v155 offset:2560
  ds_read_b64 a[20:21], v156 offset:0
  ds_read_b64 a[22:23], v156 offset:512
  ds_read_b64 a[24:25], v157 offset:0
  ds_read_b64 a[26:27], v157 offset:512
  ds_read_b64_tr_b16 a[4:5], v155 offset:32
  ds_read_b64_tr_b16 a[6:7], v155 offset:2592
  ds_read_b64_tr_b16 a[8:9], v155 offset:64
  ds_read_b64_tr_b16 a[10:11], v155 offset:2624
  ds_read_b64_tr_b16 a[12:13], v155 offset:96
  ds_read_b64_tr_b16 a[14:15], v155 offset:2656
  ds_read_b64_tr_b16 a[16:17], v155 offset:128
  ds_read_b64_tr_b16 a[18:19], v155 offset:2688
  s_mov_b32 s54, 18432
  s_add_u32 s48, s48, 1
  s_cmp_eq_u32 s48, 6
  s_cselect_b32 s54, 4294875136, s54
  s_cselect_b32 s48, 0, s48
  v_add_u32 v155, s54, v155
  v_add_u32 v156, s54, v156
  v_add_u32 v157, s54, v157
  s_waitcnt lgkmcnt(0)
Lc_109:
  s_barrier
  v_mfma_f32_16x16x32_bf16 v[104:107], a[0:3], a[20:23], v[104:107]
  ds_read_b64_tr_b16 a[28:29], v155 offset:0
  ds_read_b64_tr_b16 a[30:31], v155 offset:2560
  ds_read_b64 a[48:49], v156 offset:0
  v_mfma_f32_16x16x32_bf16 v[124:127], a[0:3], a[24:27], v[124:127]
  ds_read_b64 a[50:51], v156 offset:512
  ds_read_b64 a[52:53], v157 offset:0
  ds_read_b64 a[54:55], v157 offset:512
  v_mfma_f32_16x16x32_bf16 v[108:111], a[4:7], a[20:23], v[108:111]
  ds_read_b64_tr_b16 a[32:33], v155 offset:32
  ds_read_b64_tr_b16 a[34:35], v155 offset:2592
  ds_read_b64_tr_b16 a[36:37], v155 offset:64
  v_mfma_f32_16x16x32_bf16 v[128:131], a[4:7], a[24:27], v[128:131]
  ds_read_b64_tr_b16 a[38:39], v155 offset:2624
  ds_read_b64_tr_b16 a[40:41], v155 offset:96
  ds_read_b64_tr_b16 a[42:43], v155 offset:2656
  v_mfma_f32_16x16x32_bf16 v[112:115], a[8:11], a[20:23], v[112:115]
  ds_read_b64_tr_b16 a[44:45], v155 offset:128
  ds_read_b64_tr_b16 a[46:47], v155 offset:2688
  s_mov_b32 s54, 18432
  s_add_u32 s48, s48, 1
  s_cmp_eq_u32 s48, 6
  s_cselect_b32 s54, 4294875136, s54
  s_cselect_b32 s48, 0, s48
  v_add_u32 v155, s54, v155
  v_mfma_f32_16x16x32_bf16 v[132:135], a[8:11], a[24:27], v[132:135]
  v_add_u32 v156, s54, v156
  v_add_u32 v157, s54, v157
  v_mfma_f32_16x16x32_bf16 v[116:119], a[12:15], a[20:23], v[116:119]
  v_mfma_f32_16x16x32_bf16 v[136:139], a[12:15], a[24:27], v[136:139]
  v_mfma_f32_16x16x32_bf16 v[120:123], a[16:19], a[20:23], v[120:123]
  v_mfma_f32_16x16x32_bf16 v[140:143], a[16:19], a[24:27], v[140:143]
  s_waitcnt lgkmcnt(0)
  s_barrier
  v_mfma_f32_16x16x32_bf16 v[104:107], a[28:31], a[48:51], v[104:107]
  ds_read_b64_tr_b16 a[0:1], v155 offset:0
  ds_read_b64_tr_b16 a[2:3], v155 offset:2560
  ds_read_b64 a[20:21], v156 offset:0
  v_mfma_f32_16x16x32_bf16 v[124:127], a[28:31], a[52:55], v[124:127]
  ds_read_b64 a[22:23], v156 offset:512
  ds_read_b64 a[24:25], v157 offset:0
  ds_read_b64 a[26:27], v157 offset:512
  v_mfma_f32_16x16x32_bf16 v[108:111], a[32:35], a[48:51], v[108:111]
  ds_read_b64_tr_b16 a[4:5], v155 offset:32
  ds_read_b64_tr_b16 a[6:7], v155 offset:2592
  ds_read_b64_tr_b16 a[8:9], v155 offset:64
  v_mfma_f32_16x16x32_bf16 v[128:131], a[32:35], a[52:55], v[128:131]
  ds_read_b64_tr_b16 a[10:11], v155 offset:2624
  ds_read_b64_tr_b16 a[12:13], v155 offset:96
  ds_read_b64_tr_b16 a[14:15], v155 offset:2656
  v_mfma_f32_16x16x32_bf16 v[112:115], a[36:39], a[48:51], v[112:115]
  ds_read_b64_tr_b16 a[16:17], v155 offset:128
  ds_read_b64_tr_b16 a[18:19], v155 offset:2688
  s_mov_b32 s54, 18432
  s_add_u32 s48, s48, 1
  s_cmp_eq_u32 s48, 6
  s_cselect_b32 s54, 4294875136, s54
  s_cselect_b32 s48, 0, s48
  v_add_u32 v155, s54, v155
  v_mfma_f32_16x16x32_bf16 v[132:135], a[36:39], a[52:55], v[132:135]
  v_add_u32 v156, s54, v156
  v_add_u32 v157, s54, v157
  v_mfma_f32_16x16x32_bf16 v[116:119], a[40:43], a[48:51], v[116:119]
  v_mfma_f32_16x16x32_bf16 v[136:139], a[40:43], a[52:55], v[136:139]
  v_mfma_f32_16x16x32_bf16 v[120:123], a[44:47], a[48:51], v[120:123]
  v_mfma_f32_16x16x32_bf16 v[140:143], a[44:47], a[52:55], v[140:143]
  s_sub_u32 s47, s47, 1
  s_cmp_lg_u32 s47, 0
  s_waitcnt lgkmcnt(0)
  s_cbranch_scc1 Lc_109
  s_mov_b32 s48, 4
  s_mov_b32 s47, 13
  ds_read_b128 a[0:3], v152 offset:0
  ds_read_b64_tr_b16 a[20:21], v153 offset:0
  ds_read_b64_tr_b16 a[22:23], v153 offset:2048
  ds_read_b64_tr_b16 a[24:25], v154 offset:0
  ds_read_b64_tr_b16 a[26:27], v154 offset:2048
  ds_read_b128 a[4:7], v152 offset:2048
  ds_read_b128 a[8:11], v152 offset:4096
  ds_read_b128 a[12:15], v152 offset:6144
  ds_read_b128 a[16:19], v152 offset:8192
  s_mov_b32 s54, 18432
  s_add_u32 s48, s48, 1
  s_cmp_eq_u32 s48, 6
  s_cselect_b32 s54, 4294875136, s54
  s_cselect_b32 s48, 0, s48
  v_add_u32 v152, s54, v152
  v_add_u32 v153, s54, v153
  v_add_u32 v154, s54, v154
  s_waitcnt lgkmcnt(0)
Lc_110:
  s_barrier
  v_mfma_f32_16x16x32_bf16 v[104:107], a[0:3], a[20:23], v[104:107]
  ds_read_b128 a[28:31], v152 offset:0
  ds_read_b64_tr_b16 a[48:49], v153 offset:0
  v_mfma_f32_16x16x32_bf16 v[124:127], a[0:3], a[24:27], v[124:127]
  ds_read_b64_tr_b16 a[50:51], v153 offset:2048
  ds_read_b64_tr_b16 a[52:53], v154 offset:0
  v_mfma_f32_16x16x32_bf16 v[108:111], a[4:7], a[20:23], v[108:111]
  ds_read_b64_tr_b16 a[54:55], v154 offset:2048
  ds_read_b128 a[32:35], v152 offset:2048
  v_mfma_f32_16x16x32_bf16 v[128:131], a[4:7], a[24:27], v[128:131]
  ds_read_b128 a[36:39], v152 offset:4096
  ds_read_b128 a[40:43], v152 offset:6144
  v_mfma_f32_16x16x32_bf16 v[112:115], a[8:11], a[20:23], v[112:115]
  ds_read_b128 a[44:47], v152 offset:8192
  s_mov_b32 s54, 18432
  s_add_u32 s48, s48, 1
  s_cmp_eq_u32 s48, 6
  s_cselect_b32 s54, 4294875136, s54
  s_cselect_b32 s48, 0, s48
  v_add_u32 v152, s54, v152
  v_mfma_f32_16x16x32_bf16 v[132:135], a[8:11], a[24:27], v[132:135]
  v_add_u32 v153, s54, v153
  v_add_u32 v154, s54, v154
  v_mfma_f32_16x16x32_bf16 v[116:119], a[12:15], a[20:23], v[116:119]
  v_mfma_f32_16x16x32_bf16 v[136:139], a[12:15], a[24:27], v[136:139]
  v_mfma_f32_16x16x32_bf16 v[120:123], a[16:19], a[20:23], v[120:123]
  v_mfma_f32_16x16x32_bf16 v[140:143], a[16:19], a[24:27], v[140:143]
  s_waitcnt lgkmcnt(0)
  s_barrier
  v_mfma_f32_16x16x32_bf16 v[104:107], a[28:31], a[48:51], v[104:107]
  ds_read_b128 a[0:3], v152 offset:0
  ds_read_b64_tr_b16 a[20:21], v153 offset:0
  v_mfma_f32_16x16x32_bf16 v[124:127], a[28:31], a[52:55], v[124:127]
  ds_read_b64_tr_b16 a[22:23], v153 offset:2048
  ds_read_b64_tr_b16 a[24:25], v154 offset:0
  v_mfma_f32_16x16x32_bf16 v[108:111], a[32:35], a[48:51], v[108:111]
  ds_read_b64_tr_b16 a[26:27], v154 offset:2048
  ds_read_b128 a[4:7], v152 offset:2048
  v_mfma_f32_16x16x32_bf16 v[128:131], a[32:35], a[52:55], v[128:131]
  ds_read_b128 a[8:11], v152 offset:4096
  ds_read_b128 a[12:15], v152 offset:6144
  v_mfma_f32_16x16x32_bf16 v[112:115], a[36:39], a[48:51], v[112:115]
  ds_read_b128 a[16:19], v152 offset:8192
  s_mov_b32 s54, 18432
  s_add_u32 s48, s48, 1
  s_cmp_eq_u32 s48, 6
  s_cselect_b32 s54, 4294875136, s54
  s_cselect_b32 s48, 0, s48
  v_add_u32 v152, s54, v152
  v_mfma_f32_16x16x32_bf16 v[132:135], a[36:39], a[52:55], v[132:135]
  v_add_u32 v153, s54, v153
  v_add_u32 v154, s54, v154
  v_mfma_f32_16x16x32_bf16 v[116:119], a[40:43], a[48:51], v[116:119]
  v_mfma_f32_16x16x32_bf16 v[136:139], a[40:43], a[52:55], v[136:139]
  v_mfma_f32_16x16x32_bf16 v[120:123], a[44:47], a[48:51], v[120:123]
  v_mfma_f32_16x16x32_bf16 v[140:143], a[44:47], a[52:55], v[140:143]
  s_sub_u32 s47, s47, 1
  s_cmp_lg_u32 s47, 0
  s_waitcnt lgkmcnt(0)
  s_cbranch_scc1 Lc_110
  s_barrier
  v_mfma_f32_16x16x32_bf16 v[104:107], a[0:3], a[20:23], v[104:107]
  v_mfma_f32_16x16x32_bf16 v[124:127], a[0:3], a[24:27], v[124:127]
  v_mfma_f32_16x16x32_bf16 v[108:111], a[4:7], a[20:23], v[108:111]
  v_mfma_f32_16x16x32_bf16 v[128:131], a[4:7], a[24:27], v[128:131]
  v_mfma_f32_16x16x32_bf16 v[112:115], a[8:11], a[20:23], v[112:115]
  v_mfma_f32_16x16x32_bf16 v[132:135], a[8:11], a[24:27], v[132:135]
  v_mfma_f32_16x16x32_bf16 v[116:119], a[12:15], a[20:23], v[116:119]
  v_mfma_f32_16x16x32_bf16 v[136:139], a[12:15], a[24:27], v[136:139]
  v_mfma_f32_16x16x32_bf16 v[120:123], a[16:19], a[20:23], v[120:123]
  v_mfma_f32_16x16x32_bf16 v[140:143], a[16:19], a[24:27], v[140:143]
  s_waitcnt lgkmcnt(0)
  s_nop 7
  ds_write_b128 v174, v[124:127] offset:0
  ds_write_b128 v174, v[128:131] offset:1024
  ds_write_b128 v174, v[132:135] offset:2048
  ds_write_b128 v174, v[136:139] offset:3072
  ds_write_b128 v174, v[140:143] offset:4096
  s_waitcnt lgkmcnt(0)
  s_barrier
  ds_read_b128 v[124:127], v175 offset:0
  ds_read_b128 v[128:131], v175 offset:1024
  ds_read_b128 v[132:135], v175 offset:2048
  ds_read_b128 v[136:139], v175 offset:3072
  ds_read_b128 v[140:143], v175 offset:4096
  s_waitcnt lgkmcnt(4)
  v_pk_add_f32 v[104:105], v[104:105], v[124:125]
  v_pk_add_f32 v[106:107], v[106:107], v[126:127]
  s_waitcnt lgkmcnt(3)
  v_pk_add_f32 v[108:109], v[108:109], v[128:129]
  v_pk_add_f32 v[110:111], v[110:111], v[130:131]
  s_waitcnt lgkmcnt(2)
  v_pk_add_f32 v[112:113], v[112:113], v[132:133]
  v_pk_add_f32 v[114:115], v[114:115], v[134:135]
  s_waitcnt lgkmcnt(1)
  v_pk_add_f32 v[116:117], v[116:117], v[136:137]
  v_pk_add_f32 v[118:119], v[118:119], v[138:139]
  s_waitcnt lgkmcnt(0)
  v_pk_add_f32 v[120:121], v[120:121], v[140:141]
  v_pk_add_f32 v[122:123], v[122:123], v[142:143]
  v_cvt_pk_bf16_f32 v40, v104, v105
  v_cvt_pk_bf16_f32 v41, v106, v107
  buffer_store_dwordx2 v[40:41], v160, s[76:79], s59 offen offset:0
  v_cvt_pk_bf16_f32 v42, v108, v109
  v_cvt_pk_bf16_f32 v43, v110, v111
  buffer_store_dwordx2 v[42:43], v160, s[76:79], s59 offen offset:32
  v_cvt_pk_bf16_f32 v44, v112, v113
  v_cvt_pk_bf16_f32 v45, v114, v115
  buffer_store_dwordx2 v[44:45], v160, s[76:79], s59 offen offset:64
  v_cvt_pk_bf16_f32 v46, v116, v117
  v_cvt_pk_bf16_f32 v47, v118, v119
  buffer_store_dwordx2 v[46:47], v160, s[76:79], s59 offen offset:96
  v_cvt_pk_bf16_f32 v48, v120, v121
  v_cvt_pk_bf16_f32 v49, v122, v123
  buffer_store_dwordx2 v[48:49], v160, s[76:79], s59 offen offset:128
L_end:
  s_endpgm
.section .rodata,"a"
.p2align 6
.amdhsa_kernel parallel_sum__sliding_local_dilated__mixer_token_mlp__prompt_kernel
  .amdhsa_next_free_vgpr 256
  .amdhsa_next_free_sgpr 102
  .amdhsa_accum_offset 184
  .amdhsa_group_segment_fixed_size 0
  .amdhsa_kernarg_size 88
  .amdhsa_user_sgpr_count 2
  .amdhsa_user_sgpr_kernarg_segment_ptr 1
  .amdhsa_system_sgpr_workgroup_id_x 1
  .amdhsa_float_denorm_mode_32 3
.end_amdhsa_kernel
```
